```python
import torch

def _softmax(x, axis=-1):
    return torch.softmax(x, dim=axis)
def _gelu(x):
    return torch.nn.functional.gelu(x, approximate="tanh")
def _silu(x):
    return torch.nn.functional.silu(x)
def _sigmoid(x):
    return torch.sigmoid(x)
def _layernorm(x, axis=-1, eps=1e-5):
    m = x.mean(dim=axis, keepdim=True)
    v = x.var(dim=axis, keepdim=True, unbiased=False)
    return (x - m) / torch.sqrt(v + eps)
def _scatter_add(tgt, idx, src, axis=0):
    return tgt.clone().index_add_(axis, idx, src)
def _segment_sum(src, seg, n):
    out = torch.zeros((n,) + src.shape[1:], dtype=src.dtype)
    return out.index_add_(0, seg, src)
def _pad(x, pw):
    flat = tuple(v for pair in reversed(pw) for v in pair)
    return torch.nn.functional.pad(x, flat)

kernel_name = 'sequential_preLN__spectral_gfnet__glu_gated_geglu__prompt'

def setup_inputs():

    _w = (lambda a: (lambda t: t.to(torch.bfloat16) if t.is_floating_point() else t)(torch.as_tensor(a)))
    def _A_setup():
        B, S, D = 1, 2048, 512
        Df = D // 2 + 1
        return {
            "x": _w((lambda *s: torch.randn(*s, dtype=torch.bfloat16) * 0.05)(B, S, D)),
            "w_r": _w((lambda *s: torch.randn(*s, dtype=torch.bfloat16) * 0.4)(S, Df) * 0.02),
            "w_i": _w((lambda *s: torch.randn(*s, dtype=torch.bfloat16) * 0.4)(S, Df) * 0.02),
        }
    _A_in = _A_setup()

    def _B_setup():
        B, S, Dm, Df = 1, 2048, 512, 1792
        return {
            "x": _w((lambda *s: torch.randn(*s, dtype=torch.bfloat16) * 0.05)(B, S, Dm)),
            "w_gate": _w((lambda *s: torch.randn(*s, dtype=torch.bfloat16) * 0.4)(Dm, Df) * (Dm ** -0.5)),
            "w_up": _w((lambda *s: torch.randn(*s, dtype=torch.bfloat16) * 0.4)(Dm, Df) * (Dm ** -0.5)),
            "w_down": _w((lambda *s: torch.randn(*s, dtype=torch.bfloat16) * 0.4)(Df, Dm) * (Df ** -0.5)),
        }
    _B_in = _B_setup()

    return {
        "A_x": _A_in["x"],
        "A_w_r": _A_in["w_r"],
        "A_w_i": _A_in["w_i"],
        "B_x": _B_in["x"],
        "B_w_gate": _B_in["w_gate"],
        "B_w_up": _B_in["w_up"],
        "B_w_down": _B_in["w_down"],
    }

def reference(A_x, A_w_r, A_w_i, B_x, B_w_gate, B_w_up, B_w_down):
    def _A_ref(x, w_r, w_i):
        B, S, D = x.shape
        X = (lambda x, axes=(-2,-1): torch.fft.rfft2(x.float(), dim=axes))(x, axes=(-2, -1))
        W = w_r + 1j * w_i
        X = X * W
        y = (lambda x, s, axes=(-2,-1): torch.fft.irfft2(x, s=s, dim=axes).to(torch.bfloat16))(X, (S, D), axes=(-2, -1))
        return y

    def _B_ref(x, w_gate, w_up, w_down):
        g = torch.einsum("bsd,df->bsf", x, w_gate)
        u = torch.einsum("bsd,df->bsf", x, w_up)
        h = _gelu(g) * u
        return torch.einsum("bsf,fd->bsd", h, w_down)

    x = A_x
    h = x + _A_ref(_layernorm(x, axis=-1), A_w_r, A_w_i)
    h2 = h + _B_ref(_layernorm(h, axis=-1), B_w_gate, B_w_up, B_w_down)
    return h2
```

```asm
; @launch grid=(256,1,1) block=(512,1,1) lds=163840
.amdgcn_target "amdgcn-amd-amdhsa--gfx950"
.text
.globl sequential_preLN__spectral_gfnet__glu_gated_geglu__prompt_kernel
.p2align 8
.type sequential_preLN__spectral_gfnet__glu_gated_geglu__prompt_kernel,@function
sequential_preLN__spectral_gfnet__glu_gated_geglu__prompt_kernel:
    s_cmp_lt_u32 s2, 256
    s_cbranch_scc1 Lgo
    s_endpgm
LSTUB:
    s_mov_b32 s26, 1052672
    s_mov_b32 s27, 0x20000
    v_min_u32 v6, 8, v4
    v_lshlrev_b32 v6, 6, v6
    v_mul_u32_u24 v7, 4112, v5
    v_add_u32 v6, v6, v7
    s_lshl_b32 s47, s54, 1
    s_and_b32 s48, s45, 1
    s_add_u32 s47, s47, s48
    s_lshl_b32 s47, s47, 5
    s_add_u32 s47, s47, s53
    s_mul_i32 s47, s47, 514
    s_cmp_lt_u32 s45, 2
    s_waitcnt lgkmcnt(0)
    s_cselect_b64 s[24:25], s[6:7], s[8:9]
    s_barrier
    buffer_load_ushort v33, v6, s[24:27], s47 offen
    s_branch LPATH
Lgo:
    s_load_dwordx16 s[4:19], s[0:1], 0
    s_load_dwordx2 s[20:21], s[0:1], 72
    s_getpc_b64 s[58:59]
    v_lshlrev_b32 v6, 7, v0
    v_min_u32 v8, CODE_END-Lgo-64, v6
    v_mov_b32 v9, s59
    v_add_co_u32 v8, vcc, s58, v8
    s_nop 1
    v_addc_co_u32 v9, vcc, 0, v9, vcc
    global_load_dword v127, v[8:9], off
    v_lshrrev_b32 v6, 6, v0
    v_and_b32 v1, 63, v0
    v_readfirstlane_b32 s44, v6
    v_lshlrev_b32 v2, 4, v1
    v_and_b32 v4, 15, v0
    v_lshrrev_b32 v5, 4, v1
    s_and_b32 s53, s2, 7
    s_lshr_b32 s54, s2, 3
    s_lshl_b32 s55, s53, 5
    s_add_u32 s55, s55, s54
    s_and_b32 s45, s44, 3
    s_mov_b32 s50, 0
    s_mov_b32 s51, 0
    s_and_b32 s47, s55, 96
    s_and_b32 s48, s55, 24
    s_andn2_b32 s46, s55, 120
    s_lshr_b32 s47, s47, 2
    s_lshl_b32 s48, s48, 2
    s_or_b32 s46, s46, s47
    s_or_b32 s46, s46, s48
    s_lshl_b32 s47, s44, 2
    s_add_u32 s47, s47, 157696
    v_lshl_add_u32 v10, v1, 2, 64
    v_add_u32 v10, 157696, v10
    v_mov_b32 v11, 0
    v_writelane_b32 v10, s47, 0
    ds_write_b32 v10, v11
    s_cmp_ge_u32 s44, 4
    s_cbranch_scc1 LSTUB
    s_setprio 3
    v_lshlrev_b32 v12, 2, v1
    s_lshl_b32 s47, s45, 9
    s_add_u32 s47, s47, s46
    s_lshl_b32 s68, s47, 10
    s_add_u32 s69, s68, 262144
    s_mov_b32 s26, 2097152
    s_mov_b32 s27, 0x20000
    s_mov_b32 s30, 33554432
    s_mov_b32 s31, 0x20000
    s_mov_b32 s38, 2097152
    s_mov_b32 s39, 0x20000
    v_cvt_f32_u32 v13, v4
    v_cvt_f32_u32 v14, v5
    v_and_b32 v6, 3, v4
    v_lshrrev_b32 v7, 2, v4
    v_lshl_add_u32 v6, v6, 2, v7
    v_cvt_f32_u32 v15, v6
    s_waitcnt lgkmcnt(0)
    s_mov_b64 s[24:25], s[4:5]
    buffer_load_dword v36, v12, s[24:27], s68 offen offset:0
    buffer_load_dword v37, v12, s[24:27], s68 offen offset:256
    buffer_load_dword v38, v12, s[24:27], s68 offen offset:512
    buffer_load_dword v39, v12, s[24:27], s68 offen offset:768
    buffer_load_dword v40, v12, s[24:27], s69 offen offset:0
    buffer_load_dword v41, v12, s[24:27], s69 offen offset:256
    buffer_load_dword v42, v12, s[24:27], s69 offen offset:512
    buffer_load_dword v43, v12, s[24:27], s69 offen offset:768
    s_barrier
    s_load_dword s56, s[20:21], 524288
    s_mov_b64 s[28:29], s[20:21]
    s_mov_b64 s[36:37], s[18:19]
    v_mul_f32 v6, 0x3d800000, v13
    v_mul_f32 v7, 4.0, v6
    v_mul_f32 v6, v6, v14
    v_add_f32 v77, v6, v7
    v_fma_f32 v78, v7, 2.0, v6
    v_fma_f32 v79, v7, 2.0, v77
    v_cos_f32 v80, v6
    v_cos_f32 v81, v77
    v_cos_f32 v82, v78
    v_cos_f32 v83, v79
    v_sin_f32 v76, v6
    v_sin_f32 v77, v77
    v_sin_f32 v78, v78
    v_sin_f32 v79, v79
    v_cvt_pk_bf16_f32 v84, v80, v76
    v_cvt_pk_bf16_f32 v88, -v76, v80
    v_cvt_pk_bf16_f32 v85, v81, v77
    v_cvt_pk_bf16_f32 v89, -v77, v81
    v_cvt_pk_bf16_f32 v86, v82, v78
    v_cvt_pk_bf16_f32 v90, -v78, v82
    v_cvt_pk_bf16_f32 v87, v83, v79
    v_cvt_pk_bf16_f32 v91, -v79, v83
    v_mul_f32 v7, 0x3b800000, v13
    v_mul_f32 v6, 4.0, v14
    v_mul_f32 v6, v6, v7
    v_add_f32 v77, v6, v7
    v_fma_f32 v78, v7, 2.0, v6
    v_fma_f32 v79, v7, 2.0, v77
    v_cos_f32 v80, v6
    v_cos_f32 v81, v77
    v_cos_f32 v82, v78
    v_cos_f32 v83, v79
    v_sin_f32 v76, v6
    v_sin_f32 v77, v77
    v_sin_f32 v78, v78
    v_sin_f32 v79, v79
    v_fma_f32 v6, v7, 0.5, v6
    v_add_f32 v93, v6, v7
    v_fma_f32 v94, v7, 2.0, v6
    v_fma_f32 v95, v7, 2.0, v93
    v_cos_f32 v96, v6
    v_cos_f32 v97, v93
    v_cos_f32 v98, v94
    v_cos_f32 v99, v95
    v_sin_f32 v92, v6
    v_sin_f32 v93, v93
    v_sin_f32 v94, v94
    v_sin_f32 v95, v95
    v_mul_f32 v7, 0x3d800000, v15
    v_mul_f32 v6, 4.0, v14
    v_mul_f32 v6, v6, v7
    v_add_f32 v101, v6, v7
    v_fma_f32 v102, v7, 2.0, v6
    v_fma_f32 v103, v7, 2.0, v101
    v_cos_f32 v104, v6
    v_cos_f32 v105, v101
    v_cos_f32 v106, v102
    v_cos_f32 v107, v103
    v_sin_f32 v100, v6
    v_sin_f32 v101, v101
    v_sin_f32 v102, v102
    v_sin_f32 v103, v103
    v_cvt_pk_bf16_f32 v108, v104, v100
    v_cvt_pk_bf16_f32 v112, -v100, v104
    v_cvt_pk_bf16_f32 v109, v105, v101
    v_cvt_pk_bf16_f32 v113, -v101, v105
    v_cvt_pk_bf16_f32 v110, v106, v102
    v_cvt_pk_bf16_f32 v114, -v102, v106
    v_cvt_pk_bf16_f32 v111, v107, v103
    v_cvt_pk_bf16_f32 v115, -v103, v107
    v_fma_f32 v6, v7, 0.5, v6
    v_add_f32 v101, v6, v7
    v_fma_f32 v102, v7, 2.0, v6
    v_fma_f32 v103, v7, 2.0, v101
    v_cos_f32 v104, v6
    v_cos_f32 v105, v101
    v_cos_f32 v106, v102
    v_cos_f32 v107, v103
    v_sin_f32 v100, v6
    v_sin_f32 v101, v101
    v_sin_f32 v102, v102
    v_sin_f32 v103, v103
    v_cvt_pk_bf16_f32 v116, v104, v100
    v_cvt_pk_bf16_f32 v120, -v100, v104
    v_cvt_pk_bf16_f32 v117, v105, v101
    v_cvt_pk_bf16_f32 v121, -v101, v105
    v_cvt_pk_bf16_f32 v118, v106, v102
    v_cvt_pk_bf16_f32 v122, -v102, v106
    v_cvt_pk_bf16_f32 v119, v107, v103
    v_cvt_pk_bf16_f32 v123, -v103, v107
    v_cvt_f32_u32 v18, s46
    v_lshrrev_b32 v6, 1, v4
    v_and_b32 v7, 1, v4
    v_cvt_f32_u32 v6, v6
    v_cvt_f32_u32 v7, v7
    v_mul_f32 v18, 0x3a000000, v18
    v_mul_f32 v7, 0x3e800000, v7
    v_mul_f32 v8, 0x3e800000, v14
    v_add_f32 v8, v8, v18
    v_fma_f32 v7, v8, v6, v7
    v_mul_f32 v6, 0x3e000000, v6
    v_add_f32 v6, v6, v7
    v_cos_f32 v44, v7
    v_sin_f32 v45, v7
    v_sin_f32 v47, v6
    v_cos_f32 v46, v6
    v_sub_f32 v6, v44, v47
    v_add_f32 v8, v44, v47
    v_add_f32 v7, v45, v46
    v_sub_f32 v9, v46, v45
    v_mul_f32 v6, 0x0d800000, v6
    v_mul_f32 v7, 0x0d800000, v7
    v_mul_f32 v8, 0x0d800000, v8
    v_mul_f32 v9, 0x0d800000, v9
    v_cvt_pk_bf16_f32 v16, v6, v7
    v_cvt_pk_bf16_f32 v17, v8, v9
    s_mul_i32 s47, s45, 2052
    s_add_u32 s47, s47, 131072
    v_add_u32 v15, s47, v12
    v_mul_u32_u24 v6, 2052, v5
    v_lshlrev_b32 v7, 4, v4
    s_lshl_b32 s47, s45, 8
    s_add_u32 s48, s47, 131076
    s_sub_u32 s47, 133104, s47
    v_add3_u32 v100, v6, v7, s48
    v_sub_u32 v6, v6, v7
    v_add_u32 v101, s47, v6
    s_mul_i32 s67, s46, 8320
    s_lshl_b32 s48, s45, 11
    s_add_u32 s67, s67, s48
    s_add_u32 s67, s67, 1048576
    v_and_b32 v19, 12, v12
    v_add_u32 v19, 157696, v19
    s_waitcnt lgkmcnt(0)
    s_bfe_u32 s47, s56, 0x2000d
    s_bfe_u32 s48, s56, 0x2001d
    s_lshl_b32 s47, 1, s47
    s_lshl_b32 s48, 1, s48
    s_or_b32 s47, s47, s48
    s_ff0_i32_b32 s56, s47
    s_mul_i32 s57, s56, 0x20002000
    v_mov_b32 v3, 1610637312
    s_waitcnt vmcnt(7)
    v_lshlrev_b32 v20, 16, v36
    v_and_b32 v24, 0xffff0000, v36
    s_waitcnt vmcnt(6)
    v_lshlrev_b32 v21, 16, v37
    v_and_b32 v25, 0xffff0000, v37
    s_waitcnt vmcnt(5)
    v_lshlrev_b32 v22, 16, v38
    v_and_b32 v26, 0xffff0000, v38
    s_waitcnt vmcnt(4)
    v_lshlrev_b32 v23, 16, v39
    v_and_b32 v27, 0xffff0000, v39
    s_waitcnt vmcnt(3)
    v_lshlrev_b32 v28, 16, v40
    v_and_b32 v32, 0xffff0000, v40
    s_waitcnt vmcnt(2)
    v_lshlrev_b32 v29, 16, v41
    v_and_b32 v33, 0xffff0000, v41
    s_waitcnt vmcnt(1)
    v_lshlrev_b32 v30, 16, v42
    v_and_b32 v34, 0xffff0000, v42
    s_waitcnt vmcnt(0)
    v_lshlrev_b32 v31, 16, v43
    v_and_b32 v35, 0xffff0000, v43
    v_pk_add_f32 v[44:45], v[20:21], v[22:23]
    v_pk_mul_f32 v[46:47], v[20:21], v[20:21]
    v_pk_add_f32 v[48:49], v[28:29], v[30:31]
    v_pk_mul_f32 v[50:51], v[28:29], v[28:29]
    v_pk_fma_f32 v[46:47], v[22:23], v[22:23], v[46:47]
    v_pk_fma_f32 v[50:51], v[30:31], v[30:31], v[50:51]
    v_pk_add_f32 v[44:45], v[44:45], v[24:25]
    v_pk_fma_f32 v[46:47], v[24:25], v[24:25], v[46:47]
    v_pk_add_f32 v[48:49], v[48:49], v[32:33]
    v_pk_fma_f32 v[50:51], v[32:33], v[32:33], v[50:51]
    v_pk_add_f32 v[44:45], v[44:45], v[26:27]
    v_pk_fma_f32 v[46:47], v[26:27], v[26:27], v[46:47]
    v_pk_add_f32 v[48:49], v[48:49], v[34:35]
    v_pk_fma_f32 v[50:51], v[34:35], v[34:35], v[50:51]
    v_add_f32 v44, v44, v45
    v_add_f32 v48, v48, v49
    v_add_f32 v46, v46, v47
    v_add_f32 v50, v50, v51
    v_permlane32_swap_b32 v44, v48
    s_nop 0
    v_permlane32_swap_b32 v46, v50
    v_add_f32 v44, v44, v48
    v_add_f32 v46, v46, v50
    s_nop 0
    v_add_f32_dpp v44, v44, v44 row_ror:8 row_mask:0xf bank_mask:0xf
    v_add_f32_dpp v46, v46, v46 row_ror:8 row_mask:0xf bank_mask:0xf
    s_nop 0
    v_add_f32_dpp v44, v44, v44 row_ror:4 row_mask:0xf bank_mask:0xf
    v_add_f32_dpp v46, v46, v46 row_ror:4 row_mask:0xf bank_mask:0xf
    s_nop 0
    v_add_f32_dpp v44, v44, v44 row_ror:2 row_mask:0xf bank_mask:0xf
    v_add_f32_dpp v46, v46, v46 row_ror:2 row_mask:0xf bank_mask:0xf
    s_nop 0
    v_add_f32_dpp v44, v44, v44 row_ror:1 row_mask:0xf bank_mask:0xf
    v_add_f32_dpp v46, v46, v46 row_ror:1 row_mask:0xf bank_mask:0xf
    s_nop 0
    v_add_f32_dpp v44, v44, v44 row_bcast:15 row_mask:0xa bank_mask:0xf
    v_add_f32_dpp v46, v46, v46 row_bcast:15 row_mask:0xa bank_mask:0xf
    v_mul_f32 v44, 0x3b000000, v44
    v_mul_f32 v46, 0x3b000000, v46
    v_fma_f32 v46, -v44, v44, v46
    v_max_f32 v46, 0, v46
    v_add_f32 v46, 0x3727c5ac, v46
    v_rsq_f32 v46, v46
    s_nop 0
    v_mul_f32 v44, -v44, v46
    v_readlane_b32 s68, v46, 31
    v_readlane_b32 s69, v44, 31
    v_readlane_b32 s70, v46, 63
    v_readlane_b32 s71, v44, 63
    v_pk_fma_f32 v[60:61], v[20:21], s[68:69], s[68:69] op_sel:[0,0,1] op_sel_hi:[1,0,1]
    v_pk_fma_f32 v[62:63], v[22:23], s[68:69], s[68:69] op_sel:[0,0,1] op_sel_hi:[1,0,1]
    v_pk_fma_f32 v[64:65], v[24:25], s[68:69], s[68:69] op_sel:[0,0,1] op_sel_hi:[1,0,1]
    v_pk_fma_f32 v[66:67], v[26:27], s[68:69], s[68:69] op_sel:[0,0,1] op_sel_hi:[1,0,1]
    v_pk_fma_f32 v[68:69], v[28:29], s[70:71], s[70:71] op_sel:[0,0,1] op_sel_hi:[1,0,1]
    v_pk_fma_f32 v[70:71], v[30:31], s[70:71], s[70:71] op_sel:[0,0,1] op_sel_hi:[1,0,1]
    v_pk_fma_f32 v[72:73], v[32:33], s[70:71], s[70:71] op_sel:[0,0,1] op_sel_hi:[1,0,1]
    v_pk_fma_f32 v[74:75], v[34:35], s[70:71], s[70:71] op_sel:[0,0,1] op_sel_hi:[1,0,1]
    v_cvt_pk_bf16_f32 v36, v60, v68
    v_cvt_pk_bf16_f32 v37, v61, v69
    v_cvt_pk_bf16_f32 v38, v62, v70
    v_cvt_pk_bf16_f32 v39, v63, v71
    v_cvt_pk_bf16_f32 v40, v64, v72
    v_cvt_pk_bf16_f32 v41, v65, v73
    v_cvt_pk_bf16_f32 v42, v66, v74
    v_cvt_pk_bf16_f32 v43, v67, v75
    v_mfma_f32_16x16x32_bf16 v[44:47], v[36:39], v[84:87], 0
    v_mfma_f32_16x16x32_bf16 v[48:51], v[36:39], v[88:91], 0
    v_mfma_f32_16x16x32_bf16 v[52:55], v[40:43], v[84:87], 0
    v_mfma_f32_16x16x32_bf16 v[56:59], v[40:43], v[88:91], 0
    s_nop 4
    v_pk_mul_f32 v[102:103], v[44:45], v[80:81]
    v_pk_mul_f32 v[104:105], v[46:47], v[82:83]
    v_pk_mul_f32 v[44:45], v[44:45], v[76:77] neg_lo:[1,0] neg_hi:[1,0]
    v_pk_mul_f32 v[46:47], v[46:47], v[78:79] neg_lo:[1,0] neg_hi:[1,0]
    v_pk_fma_f32 v[102:103], v[48:49], v[76:77], v[102:103]
    v_pk_fma_f32 v[44:45], v[48:49], v[80:81], v[44:45]
    v_pk_fma_f32 v[104:105], v[50:51], v[78:79], v[104:105]
    v_pk_fma_f32 v[46:47], v[50:51], v[82:83], v[46:47]
    v_cvt_pk_bf16_f32 v36, v102, v44
    v_cvt_pk_bf16_f32 v37, v103, v45
    v_cvt_pk_bf16_f32 v38, v104, v46
    v_cvt_pk_bf16_f32 v39, v105, v47
    s_nop 1
    v_mfma_f32_16x16x32_bf16 v[60:63], v[108:111], v[36:39], 0
    v_mfma_f32_16x16x32_bf16 v[64:67], v[112:115], v[36:39], 0
    v_pk_mul_f32 v[102:103], v[52:53], v[96:97]
    v_pk_mul_f32 v[104:105], v[54:55], v[98:99]
    v_pk_mul_f32 v[52:53], v[52:53], v[92:93] neg_lo:[1,0] neg_hi:[1,0]
    v_pk_mul_f32 v[54:55], v[54:55], v[94:95] neg_lo:[1,0] neg_hi:[1,0]
    v_pk_fma_f32 v[102:103], v[56:57], v[92:93], v[102:103]
    v_pk_fma_f32 v[52:53], v[56:57], v[96:97], v[52:53]
    v_pk_fma_f32 v[104:105], v[58:59], v[94:95], v[104:105]
    v_pk_fma_f32 v[54:55], v[58:59], v[98:99], v[54:55]
    v_cvt_pk_bf16_f32 v40, v102, v52
    v_cvt_pk_bf16_f32 v41, v103, v53
    v_cvt_pk_bf16_f32 v42, v104, v54
    v_cvt_pk_bf16_f32 v43, v105, v55
    s_nop 1
    v_mfma_f32_16x16x32_bf16 v[68:71], v[116:119], v[40:43], 0
    v_mfma_f32_16x16x32_bf16 v[72:75], v[120:123], v[40:43], 0
    s_nop 6
    v_pk_add_f32 v[44:45], v[60:61], v[68:69]
    v_pk_add_f32 v[46:47], v[62:63], v[70:71]
    v_pk_add_f32 v[48:49], v[64:65], v[72:73]
    v_pk_add_f32 v[50:51], v[66:67], v[74:75]
    v_cvt_pk_bf16_f32 v36, v44, v48
    v_cvt_pk_bf16_f32 v37, v45, v49
    v_cvt_pk_bf16_f32 v38, v46, v50
    v_cvt_pk_bf16_f32 v39, v47, v51
    ds_write2st64_b32 v15, v36, v37 offset0:0 offset1:1
    ds_write2st64_b32 v15, v38, v39 offset0:2 offset1:3
    v_pk_add_f32 v[52:53], v[60:61], v[68:69] neg_lo:[0,1] neg_hi:[0,1]
    v_pk_add_f32 v[54:55], v[62:63], v[70:71] neg_lo:[0,1] neg_hi:[0,1]
    v_pk_add_f32 v[56:57], v[64:65], v[72:73] neg_lo:[0,1] neg_hi:[0,1]
    v_pk_add_f32 v[58:59], v[66:67], v[74:75] neg_lo:[0,1] neg_hi:[0,1]
    v_cvt_pk_bf16_f32 v40, v52, v56
    v_cvt_pk_bf16_f32 v41, v53, v57
    v_cvt_pk_bf16_f32 v42, v54, v58
    v_cvt_pk_bf16_f32 v43, v55, v59
    ds_write2st64_b32 v15, v40, v41 offset0:4 offset1:5
    ds_write2st64_b32 v15, v42, v43 offset0:6 offset1:7
    v_mov_b32 v11, 2
    ds_write_b32 v10, v11
Sy2:
    ds_read_b32 v9, v19
    ds_read_b32 v68, v100 offset:0
    ds_read_b32 v69, v101 offset:12
    ds_read_b32 v70, v100 offset:4
    ds_read_b32 v71, v101 offset:8
    ds_read_b32 v72, v100 offset:8
    ds_read_b32 v73, v101 offset:4
    ds_read_b32 v74, v100 offset:12
    ds_read_b32 v75, v101 offset:0
    s_add_u32 s51, s51, 1
    s_cmp_lt_u32 s51, 3200000
    s_cbranch_scc0 Sy2c
    s_waitcnt lgkmcnt(8)
    v_cmp_gt_u32 vcc, 2, v9
    s_nop 0
    s_cbranch_vccnz Sy2
Sy2c:
    s_waitcnt lgkmcnt(6)
    v_mfma_f32_16x16x16_bf16 v[44:47], v[16:17], v[68:69], 0
    s_waitcnt lgkmcnt(4)
    v_mfma_f32_16x16x16_bf16 v[48:51], v[16:17], v[70:71], 0
    s_waitcnt lgkmcnt(2)
    v_mfma_f32_16x16x16_bf16 v[52:55], v[16:17], v[72:73], 0
    s_waitcnt lgkmcnt(0)
    v_mfma_f32_16x16x16_bf16 v[56:59], v[16:17], v[74:75], 0
    s_nop 1
    v_cvt_pk_bf16_f32 v60, v44, v45
    s_nop 0
    v_cvt_pk_bf16_f32 v61, v48, v49
    s_nop 0
    v_cvt_pk_bf16_f32 v62, v52, v53
    s_nop 0
    v_cvt_pk_bf16_f32 v63, v56, v57
    v_bfi_b32 v60, v3, s57, v60
    v_bfi_b32 v61, v3, s57, v61
    v_bfi_b32 v62, v3, s57, v62
    v_bfi_b32 v63, v3, s57, v63
    buffer_store_dwordx4 v[60:63], v2, s[28:31], s67 offen offset:0 sc1
    v_cvt_pk_bf16_f32 v64, v46, v47
    v_cvt_pk_bf16_f32 v65, v50, v51
    v_cvt_pk_bf16_f32 v66, v54, v55
    v_cvt_pk_bf16_f32 v67, v58, v59
    v_bfi_b32 v64, v3, s57, v64
    v_bfi_b32 v65, v3, s57, v65
    v_bfi_b32 v66, v3, s57, v66
    v_bfi_b32 v67, v3, s57, v67
    buffer_store_dwordx4 v[64:67], v2, s[28:31], s67 offen offset:1024 sc1
    v_mov_b32 v11, 3
    ds_write_b32 v10, v11
    v_fma_f32 v9, v13, 2.0, 1.0
    v_mul_f32 v6, 0x3d000000, v9
    v_mul_f32 v7, 4.0, v6
    v_mul_f32 v6, v6, v14
    v_add_f32 v93, v6, v7
    v_fma_f32 v94, v7, 2.0, v6
    v_fma_f32 v95, v7, 2.0, v93
    v_cos_f32 v96, v6
    v_cos_f32 v97, v93
    v_cos_f32 v98, v94
    v_cos_f32 v99, v95
    v_sin_f32 v92, v6
    v_sin_f32 v93, v93
    v_sin_f32 v94, v94
    v_sin_f32 v95, v95
    v_cvt_pk_bf16_f32 v116, v96, v92
    v_cvt_pk_bf16_f32 v120, -v92, v96
    v_cvt_pk_bf16_f32 v117, v97, v93
    v_cvt_pk_bf16_f32 v121, -v93, v97
    v_cvt_pk_bf16_f32 v118, v98, v94
    v_cvt_pk_bf16_f32 v122, -v94, v98
    v_cvt_pk_bf16_f32 v119, v99, v95
    v_cvt_pk_bf16_f32 v123, -v95, v99
    v_xor_b32 v96, 0x80008000, v116
    v_xor_b32 v92, 0x80008000, v120
    v_xor_b32 v97, 0x80008000, v117
    v_xor_b32 v93, 0x80008000, v121
    v_xor_b32 v98, 0x80008000, v118
    v_xor_b32 v94, 0x80008000, v122
    v_xor_b32 v99, 0x80008000, v119
    v_xor_b32 v95, 0x80008000, v123
    v_accvgpr_write_b32 a112, v116
    v_accvgpr_write_b32 a113, v117
    v_accvgpr_write_b32 a114, v118
    v_accvgpr_write_b32 a115, v119
    v_accvgpr_write_b32 a116, v120
    v_accvgpr_write_b32 a117, v121
    v_accvgpr_write_b32 a118, v122
    v_accvgpr_write_b32 a119, v123
    v_accvgpr_write_b32 a120, v96
    v_accvgpr_write_b32 a121, v97
    v_accvgpr_write_b32 a122, v98
    v_accvgpr_write_b32 a123, v99
    v_accvgpr_write_b32 a124, v92
    v_accvgpr_write_b32 a125, v93
    v_accvgpr_write_b32 a126, v94
    v_accvgpr_write_b32 a127, v95
    v_lshrrev_b32 v6, 2, v4
    v_cvt_f32_u32 v6, v6
    v_mul_f32 v48, 0x3e800000, v6
    v_add_f32 v48, v48, v18
    v_bfe_u32 v6, v4, 1, 1
    v_and_b32 v7, 1, v4
    v_cvt_f32_u32 v6, v6
    v_cvt_f32_u32 v7, v7
    v_fma_f32 v6, v6, 2.0, -1.0
    v_mul_f32 v6, 0x3e800000, v6
    v_mul_f32 v49, v6, v7
    v_fma_f32 v7, v14, 2.0, 0
    v_fma_f32 v8, v48, v7, v49
    v_mul_f32 v7, 0x3e000000, v7
    v_sub_f32 v7, v7, v6
    v_add_f32 v7, v7, v8
    v_cos_f32 v44, v8
    v_sin_f32 v45, v8
    v_cos_f32 v46, v7
    v_sin_f32 v47, v7
    v_add_f32 v7, v44, v46
    v_add_f32 v8, v45, v47
    v_mul_f32 v7, 0x67000000, v7
    v_mul_f32 v8, 0xe7000000, v8
    v_cvt_pk_bf16_f32 v16, v7, v8
    v_fma_f32 v7, v14, 2.0, 1.0
    v_fma_f32 v8, v48, v7, v49
    v_mul_f32 v7, 0x3e000000, v7
    v_sub_f32 v7, v7, v6
    v_add_f32 v7, v7, v8
    v_cos_f32 v44, v8
    v_sin_f32 v45, v8
    v_cos_f32 v46, v7
    v_sin_f32 v47, v7
    v_add_f32 v7, v44, v46
    v_add_f32 v8, v45, v47
    v_mul_f32 v7, 0x67000000, v7
    v_mul_f32 v8, 0xe7000000, v8
    v_cvt_pk_bf16_f32 v17, v7, v8
    s_lshl_b32 s47, s45, 2
    s_add_u32 s47, s47, 149504
    v_add_u32 v15, s47, v2
    s_mul_i32 s67, s2, 8320
    s_lshl_b32 s48, s45, 11
    s_add_u32 s67, s67, s48
    s_add_u32 s67, s67, 6291456
    v_lshrrev_b32 v7, 1, v1
    v_and_b32 v8, 1, v1
    v_mul_u32_u24 v18, 8320, v7
    v_lshl_add_u32 v18, v8, 4, v18
    v_mul_u32_u24 v100, 4160, v8
    v_lshl_add_u32 v100, v7, 3, v100
    s_lshl_b32 s47, s45, 8
    s_add_u32 s47, s47, 140288
    v_add_u32 v100, s47, v100
    s_lshl_b32 s47, s45, 11
    s_lshr_b32 s48, s45, 1
    s_lshl_b32 s48, s48, 6
    s_add_u32 s47, s47, s48
    s_add_u32 s47, s47, 140288
    v_lshl_add_u32 v101, v1, 3, s47
    s_lshr_b32 s47, s54, 3
    s_lshl_b32 s47, s47, 11
    s_and_b32 s48, s53, 1
    s_lshl_b32 s48, s48, 10
    s_add_u32 s47, s47, s48
    s_lshr_b32 s48, s53, 1
    s_lshl_b32 s48, s48, 8
    s_add_u32 s47, s47, s48
    s_and_b32 s48, s54, 7
    s_lshl_b32 s48, s48, 5
    s_add_u32 s47, s47, s48
    s_and_b32 s48, s45, 1
    s_lshr_b32 s49, s45, 1
    s_lshl_b32 s49, s49, 2
    s_add_u32 s48, s48, s49
    s_mul_i32 s48, s48, 266240
    s_add_u32 s47, s47, s48
    s_add_u32 s72, s47, 1048576
    s_add_u32 s73, s47, 1581056
    v_and_b32 v7, 96, v1
    v_and_b32 v8, 24, v1
    v_and_b32 v6, 135, v1
    v_lshrrev_b32 v7, 2, v7
    v_lshlrev_b32 v8, 2, v8
    v_or3_b32 v6, v6, v7, v8
    s_lshl_b32 s47, s45, 3
    s_add_u32 s47, s47, 131072
    v_and_b32 v7, 4, v6
    v_lshlrev_b32 v7, 2, v7
    v_lshl_add_u32 v6, v6, 5, s47
    v_xor_b32 v106, v6, v7
    v_bfe_u32 v6, v1, 3, 1
    v_xor_b32 v6, v6, v1
    s_lshl_b32 s47, s45, 11
    s_add_u32 s47, s47, 131072
    v_lshl_add_u32 v107, v6, 4, s47
    s_and_b32 s58, s46, 1
    s_bfe_u32 s47, s46, 0x40001
    s_mul_i32 s59, s47, 7
    s_mul_i32 s47, s58, 3
    s_add_u32 s59, s59, s47
    s_lshr_b32 s47, s46, 5
    s_lshl_b32 s47, s47, 3
    s_lshl_b32 s48, s45, 1
    s_add_u32 s47, s47, s48
    s_add_u32 s60, s47, s58
    s_and_b32 s66, s53, 1
    s_lshr_b32 s47, s53, 1
    s_lshl_b32 s47, s47, 2
    s_lshr_b32 s48, s54, 3
    s_add_u32 s61, s47, s48
    s_and_b32 s62, s54, 7
    s_mul_i32 s63, s46, 8320
    s_lshl_b32 s48, s45, 11
    s_add_u32 s63, s63, s48
    s_add_u32 s63, s63, 11534336
    s_waitcnt vmcnt(0)
    v_mov_b32 v11, 4
    ds_write_b32 v10, v11
    buffer_load_dwordx4 v[44:47], v18, s[28:31], s72 offen sc1
    buffer_load_dwordx4 v[48:51], v18, s[28:31], s73 offen sc1
    v_mov_b32 v11, 5
    ds_write_b32 v10, v11
    s_waitcnt vmcnt(1)
    v_xor_b32 v36, s57, v44
    v_xor_b32 v38, s57, v45
    v_xor_b32 v40, s57, v46
    v_xor_b32 v42, s57, v47
    v_or3_b32 v6, v36, v38, v40
    s_waitcnt vmcnt(0)
    v_xor_b32 v37, s57, v48
    v_xor_b32 v39, s57, v49
    v_xor_b32 v41, s57, v50
    v_xor_b32 v43, s57, v51
    v_or3_b32 v7, v42, v37, v39
    v_or3_b32 v6, v6, v41, v43
    v_bitop3_b32 v6, v6, v7, v3 bitop3:0xa8
    v_cmp_ne_u32 vcc, 0, v6
    s_nop 0
    s_cbranch_vccnz R_B
C_B:
    ds_write_b64 v100, v[36:37] offset:0
    ds_write_b64 v100, v[38:39] offset:1024
    ds_write_b64 v100, v[40:41] offset:2048
    ds_write_b64 v100, v[42:43] offset:3072
    v_mov_b32 v11, 6
    ds_write_b32 v10, v11
Sy6:
    ds_read_b32 v9, v19
    ds_read_b64 v[60:61], v101 offset:0
    ds_read_b64 v[62:63], v101 offset:512
    ds_read_b64 v[64:65], v101 offset:1024
    ds_read_b64 v[66:67], v101 offset:1536
    s_add_u32 s51, s51, 1
    s_cmp_lt_u32 s51, 3200000
    s_cbranch_scc0 Sy6c
    s_waitcnt lgkmcnt(4)
    v_cmp_gt_u32 vcc, 6, v9
    s_nop 0
    s_cbranch_vccnz Sy6
Sy6c:
    s_waitcnt lgkmcnt(2)
    v_mfma_f32_16x16x32_bf16 v[44:47], v[60:63], v[84:87], 0
    v_mfma_f32_16x16x32_bf16 v[48:51], v[60:63], v[88:91], 0
    s_waitcnt lgkmcnt(0)
    v_mfma_f32_16x16x32_bf16 v[52:55], v[64:67], v[84:87], 0
    v_mfma_f32_16x16x32_bf16 v[56:59], v[64:67], v[88:91], 0
    ds_read_b32 v9, v19 offset:16
    ds_read_b32 v116, v15 offset:0
    ds_read_b32 v117, v15 offset:1024
    ds_read_b32 v118, v15 offset:2048
    ds_read_b32 v119, v15 offset:3072
    v_pk_mul_f32 v[102:103], v[44:45], v[80:81]
    v_pk_mul_f32 v[104:105], v[46:47], v[82:83]
    v_pk_mul_f32 v[44:45], v[44:45], v[76:77] neg_lo:[1,0] neg_hi:[1,0]
    v_pk_mul_f32 v[46:47], v[46:47], v[78:79] neg_lo:[1,0] neg_hi:[1,0]
    v_pk_fma_f32 v[102:103], v[48:49], v[76:77], v[102:103]
    v_pk_fma_f32 v[44:45], v[48:49], v[80:81], v[44:45]
    v_pk_fma_f32 v[104:105], v[50:51], v[78:79], v[104:105]
    v_pk_fma_f32 v[46:47], v[50:51], v[82:83], v[46:47]
    v_cvt_pk_bf16_f32 v36, v102, v44
    v_cvt_pk_bf16_f32 v37, v103, v45
    v_cvt_pk_bf16_f32 v38, v104, v46
    v_cvt_pk_bf16_f32 v39, v105, v47
    ds_read_b32 v120, v15 offset:4096
    ds_read_b32 v121, v15 offset:5120
    v_mfma_f32_16x16x32_bf16 v[60:63], v[108:111], v[36:39], 0
    v_mfma_f32_16x16x32_bf16 v[64:67], v[112:115], v[36:39], 0
    ds_read_b32 v122, v15 offset:6144
    ds_read_b32 v123, v15 offset:7168
    v_pk_mul_f32 v[102:103], v[52:53], v[80:81]
    v_pk_mul_f32 v[104:105], v[54:55], v[82:83]
    v_pk_mul_f32 v[52:53], v[52:53], v[76:77] neg_lo:[1,0] neg_hi:[1,0]
    v_pk_mul_f32 v[54:55], v[54:55], v[78:79] neg_lo:[1,0] neg_hi:[1,0]
    v_pk_fma_f32 v[102:103], v[56:57], v[76:77], v[102:103]
    v_pk_fma_f32 v[52:53], v[56:57], v[80:81], v[52:53]
    v_pk_fma_f32 v[104:105], v[58:59], v[78:79], v[104:105]
    v_pk_fma_f32 v[54:55], v[58:59], v[82:83], v[54:55]
    v_cvt_pk_bf16_f32 v40, v102, v52
    v_cvt_pk_bf16_f32 v41, v103, v53
    v_cvt_pk_bf16_f32 v42, v104, v54
    v_cvt_pk_bf16_f32 v43, v105, v55
    s_waitcnt lgkmcnt(8)
    v_cmp_gt_u32 vcc, 6, v9
    v_and_b32 v19, 28, v12
    v_mfma_f32_16x16x32_bf16 v[68:71], v[108:111], v[40:43], 0
    v_mfma_f32_16x16x32_bf16 v[72:75], v[112:115], v[40:43], 0
    s_cbranch_vccnz WSr
WSc:
    s_waitcnt lgkmcnt(7)
    v_lshlrev_b32 v92, 16, v116
    s_waitcnt lgkmcnt(6)
    v_lshlrev_b32 v93, 16, v117
    s_waitcnt lgkmcnt(5)
    v_lshlrev_b32 v94, 16, v118
    s_waitcnt lgkmcnt(4)
    v_lshlrev_b32 v95, 16, v119
    s_waitcnt lgkmcnt(3)
    v_lshlrev_b32 v96, 16, v120
    s_waitcnt lgkmcnt(2)
    v_lshlrev_b32 v97, 16, v121
    s_waitcnt lgkmcnt(1)
    v_lshlrev_b32 v98, 16, v122
    s_waitcnt lgkmcnt(0)
    v_lshlrev_b32 v99, 16, v123
    v_pk_mul_f32 v[102:103], v[60:61], v[92:93]
    v_pk_mul_f32 v[104:105], v[62:63], v[94:95]
    v_pk_mul_f32 v[60:61], v[60:61], v[96:97]
    v_pk_mul_f32 v[62:63], v[62:63], v[98:99]
    v_pk_fma_f32 v[102:103], v[64:65], v[96:97], v[102:103] neg_lo:[1,0,0] neg_hi:[1,0,0]
    v_pk_fma_f32 v[60:61], v[64:65], v[92:93], v[60:61]
    v_pk_fma_f32 v[104:105], v[66:67], v[98:99], v[104:105] neg_lo:[1,0,0] neg_hi:[1,0,0]
    v_pk_fma_f32 v[62:63], v[66:67], v[94:95], v[62:63]
    v_cvt_pk_bf16_f32 v36, v60, v102
    v_cvt_pk_bf16_f32 v37, v61, v103
    v_cvt_pk_bf16_f32 v38, v62, v104
    v_cvt_pk_bf16_f32 v39, v63, v105
    v_and_b32 v116, 0xffff0000, v116
    v_and_b32 v117, 0xffff0000, v117
    v_mfma_f32_16x16x32_bf16 v[44:47], v[36:39], v[84:87], 0
    v_mfma_f32_16x16x32_bf16 v[48:51], v[36:39], v[88:91], 0
    v_and_b32 v118, 0xffff0000, v118
    v_and_b32 v119, 0xffff0000, v119
    v_and_b32 v120, 0xffff0000, v120
    v_and_b32 v121, 0xffff0000, v121
    v_and_b32 v122, 0xffff0000, v122
    v_and_b32 v123, 0xffff0000, v123
    v_pk_mul_f32 v[102:103], v[68:69], v[116:117]
    v_pk_mul_f32 v[104:105], v[70:71], v[118:119]
    v_pk_mul_f32 v[68:69], v[68:69], v[120:121]
    v_pk_mul_f32 v[70:71], v[70:71], v[122:123]
    v_pk_fma_f32 v[102:103], v[72:73], v[120:121], v[102:103] neg_lo:[1,0,0] neg_hi:[1,0,0]
    v_pk_fma_f32 v[68:69], v[72:73], v[116:117], v[68:69]
    v_pk_fma_f32 v[104:105], v[74:75], v[122:123], v[104:105] neg_lo:[1,0,0] neg_hi:[1,0,0]
    v_pk_fma_f32 v[70:71], v[74:75], v[118:119], v[70:71]
    v_cvt_pk_bf16_f32 v40, v68, v102
    v_cvt_pk_bf16_f32 v41, v69, v103
    v_cvt_pk_bf16_f32 v42, v70, v104
    v_cvt_pk_bf16_f32 v43, v71, v105
    v_add_u32 v19, 157696, v19
    s_nop 0
    v_mfma_f32_16x16x32_bf16 v[52:55], v[40:43], v[84:87], 0
    v_mfma_f32_16x16x32_bf16 v[56:59], v[40:43], v[88:91], 0
    v_mov_b32 v11, 7
    ds_write_b32 v10, v11
    v_pk_mul_f32 v[102:103], v[44:45], v[80:81]
    v_pk_mul_f32 v[104:105], v[46:47], v[82:83]
    v_pk_mul_f32 v[44:45], v[44:45], v[76:77] neg_lo:[1,0] neg_hi:[1,0]
    v_pk_mul_f32 v[46:47], v[46:47], v[78:79] neg_lo:[1,0] neg_hi:[1,0]
    v_pk_fma_f32 v[102:103], v[48:49], v[76:77], v[102:103]
    v_pk_fma_f32 v[44:45], v[48:49], v[80:81], v[44:45]
    v_pk_fma_f32 v[104:105], v[50:51], v[78:79], v[104:105]
    v_pk_fma_f32 v[46:47], v[50:51], v[82:83], v[46:47]
    v_cvt_pk_bf16_f32 v36, v102, v44
    v_cvt_pk_bf16_f32 v37, v103, v45
    v_cvt_pk_bf16_f32 v38, v104, v46
    v_cvt_pk_bf16_f32 v39, v105, v47
    s_nop 1
    v_mfma_f32_16x16x32_bf16 v[60:63], v[108:111], v[36:39], 0
    v_mfma_f32_16x16x32_bf16 v[64:67], v[112:115], v[36:39], 0
    v_pk_mul_f32 v[102:103], v[52:53], v[80:81]
    v_pk_mul_f32 v[104:105], v[54:55], v[82:83]
    v_pk_mul_f32 v[52:53], v[52:53], v[76:77] neg_lo:[1,0] neg_hi:[1,0]
    v_pk_mul_f32 v[54:55], v[54:55], v[78:79] neg_lo:[1,0] neg_hi:[1,0]
    v_pk_fma_f32 v[102:103], v[56:57], v[76:77], v[102:103]
    v_pk_fma_f32 v[52:53], v[56:57], v[80:81], v[52:53]
    v_pk_fma_f32 v[104:105], v[58:59], v[78:79], v[104:105]
    v_pk_fma_f32 v[54:55], v[58:59], v[82:83], v[54:55]
    v_cvt_pk_bf16_f32 v40, v102, v52
    v_cvt_pk_bf16_f32 v41, v103, v53
    v_cvt_pk_bf16_f32 v42, v104, v54
    v_cvt_pk_bf16_f32 v43, v105, v55
    s_nop 1
    v_mfma_f32_16x16x32_bf16 v[68:71], v[108:111], v[40:43], 0
    v_mfma_f32_16x16x32_bf16 v[72:75], v[112:115], v[40:43], 0
    v_cvt_pk_bf16_f32 v44, v64, v60
    v_cvt_pk_bf16_f32 v46, v65, v61
    v_cvt_pk_bf16_f32 v48, v66, v62
    v_cvt_pk_bf16_f32 v50, v67, v63
    v_bfi_b32 v44, v3, s57, v44
    v_bfi_b32 v46, v3, s57, v46
    v_bfi_b32 v48, v3, s57, v48
    v_bfi_b32 v50, v3, s57, v50
    v_cvt_pk_bf16_f32 v45, v72, v68
    v_bfi_b32 v45, v3, s57, v45
    ds_write_b64 v106, v[44:45] offset:0
    v_cvt_pk_bf16_f32 v47, v73, v69
    v_bfi_b32 v47, v3, s57, v47
    ds_write_b64 v106, v[46:47] offset:512
    v_cvt_pk_bf16_f32 v49, v74, v70
    v_bfi_b32 v49, v3, s57, v49
    ds_write_b64 v106, v[48:49] offset:4096
    v_cvt_pk_bf16_f32 v51, v75, v71
    v_bfi_b32 v51, v3, s57, v51
    ds_write_b64 v106, v[50:51] offset:4608
    v_mov_b32 v11, 8
    ds_write_b32 v10, v11
Sy8:
    ds_read_b32 v9, v19
    ds_read_b128 v[52:55], v107 offset:0
    ds_read_b128 v[56:59], v107 offset:1024
    s_add_u32 s51, s51, 1
    s_cmp_lt_u32 s51, 3200000
    s_cbranch_scc0 Sy8c
    s_waitcnt lgkmcnt(2)
    v_cmp_gt_u32 vcc, 8, v9
    s_nop 0
    s_cbranch_vccnz Sy8
Sy8c:
    s_waitcnt lgkmcnt(1)
    buffer_store_dwordx4 v[52:55], v2, s[28:31], s67 offen offset:0 sc1
    s_waitcnt lgkmcnt(0)
    buffer_store_dwordx4 v[56:59], v2, s[28:31], s67 offen offset:1024 sc1
    v_mov_b32 v11, 9
    ds_write_b32 v10, v11
    v_fma_f32 v9, v13, 2.0, 1.0
    v_mul_f32 v7, 0x3b000000, v9
    v_mul_f32 v6, 4.0, v14
    v_mul_f32 v6, v6, v7
    v_add_f32 v93, v6, v7
    v_fma_f32 v94, v7, 2.0, v6
    v_fma_f32 v95, v7, 2.0, v93
    v_cos_f32 v96, v6
    v_cos_f32 v97, v93
    v_cos_f32 v98, v94
    v_cos_f32 v99, v95
    v_sin_f32 v92, v6
    v_sin_f32 v93, v93
    v_sin_f32 v94, v94
    v_sin_f32 v95, v95
    v_and_b32 v6, 0xcf, v0
    v_mov_b32 v7, 0.5
    v_cmp_eq_u32 vcc, 0xcf, v6
    v_lshrrev_b32 v6, 1, v4
    v_lshlrev_b32 v6, 2, v6
    v_cndmask_b32 v100, 1.0, v7, vcc
    v_cndmask_b32 v101, 0, v7, vcc
    v_add_u32 v6, v6, v5
    v_mul_u32_u24 v6, 16640, v6
    v_and_b32 v7, 1, v4
    v_lshl_add_u32 v15, v7, 4, v6
    s_mul_i32 s47, s45, 532480
    s_lshl_b32 s48, s55, 5
    s_add_u32 s47, s47, s48
    s_add_u32 s72, s47, 6291456
    s_add_u32 s73, s47, 6299776
    v_mul_u32_u24 v6, 2064, v5
    v_lshlrev_b32 v7, 4, v4
    s_lshl_b32 s47, s45, 8
    s_add_u32 s48, s47, 140304
    s_sub_u32 s47, 142336, s47
    v_add3_u32 v18, v6, v7, s48
    v_sub_u32 v6, v6, v7
    v_add_u32 v106, s47, v6
    s_mul_i32 s47, s45, 2064
    s_add_u32 s47, s47, 140300
    v_add_u32 v116, s47, v12
    v_add_u32 v117, 1028, v116
    v_mov_b32 v6, s47
    v_mov_b32 v7, 0
    ds_write_b32 v6, v7
    v_and_b32 v6, 7, v1
    s_lshl_b32 s47, s45, 1
    v_xor_b32 v6, s47, v6
    v_lshlrev_b32 v6, 4, v6
    v_lshl_add_u32 v6, v1, 7, v6
    v_add_u32 v118, 131072, v6
    v_xor_b32 v119, 16, v118
    v_lshrrev_b32 v6, 3, v1
    v_xor_b32 v6, v6, v1
    s_lshl_b32 s47, s45, 11
    s_add_u32 s48, s47, 131072
    v_lshl_add_u32 v107, v6, 4, s48
    s_add_u32 s48, s47, 149504
    v_add_u32 v120, s48, v12
    v_add_u32 v121, s48, v2
    s_lshl_b32 s67, s46, 13
    s_add_u32 s67, s67, s47
    s_add_u32 s67, s67, 14680064
    s_waitcnt vmcnt(0)
    v_or_b32 v8, 16, v19
Zw:
    ds_read_b32 v9, v8
    s_add_u32 s51, s51, 1
    s_cmp_lt_u32 s51, 3200000
    s_cbranch_scc0 Zwc
    s_waitcnt lgkmcnt(0)
    v_cmp_gt_u32 vcc, 101, v9
    s_nop 0
    s_cbranch_vccnz Zw
Zwc:
    buffer_load_dwordx4 v[44:47], v15, s[28:31], s72 offen sc1
    buffer_load_dwordx4 v[48:51], v15, s[28:31], s73 offen sc1
    v_mov_b32 v11, 11
    ds_write_b32 v10, v11
    s_waitcnt vmcnt(1)
    v_xor_b32 v36, s57, v44
    v_xor_b32 v38, s57, v45
    v_xor_b32 v40, s57, v46
    v_xor_b32 v42, s57, v47
    v_or3_b32 v6, v36, v38, v40
    s_waitcnt vmcnt(0)
    v_xor_b32 v37, s57, v48
    v_xor_b32 v39, s57, v49
    v_xor_b32 v41, s57, v50
    v_xor_b32 v43, s57, v51
    v_or3_b32 v7, v42, v37, v39
    v_or3_b32 v6, v6, v41, v43
    v_bitop3_b32 v6, v6, v7, v3 bitop3:0xa8
    v_cmp_ne_u32 vcc, 0, v6
    s_nop 0
    s_cbranch_vccnz R_C
C_C:
    v_mfma_f32_16x16x16_bf16 v[56:59], v[16:17], v[42:43], 0
    v_mfma_f32_16x16x16_bf16 v[44:47], v[16:17], v[36:37], 0
    v_mfma_f32_16x16x16_bf16 v[48:51], v[16:17], v[38:39], 0
    v_mfma_f32_16x16x16_bf16 v[52:55], v[16:17], v[40:41], 0
    s_nop 4
    v_pk_mul_f32 v[58:59], v[58:59], v[100:101] op_sel:[0,0] op_sel_hi:[1,0]
    v_pk_fma_f32 v[58:59], v[56:57], v[100:101], v[58:59] op_sel:[0,1,0] op_sel_hi:[1,1,1]
    v_cvt_pk_bf16_f32 v63, v57, v56
    v_cvt_pk_bf16_f32 v60, v45, v44
    v_cvt_pk_bf16_f32 v61, v49, v48
    v_cvt_pk_bf16_f32 v62, v53, v52
    ds_write_b128 v18, v[60:63]
    v_cvt_pk_bf16_f32 v64, v59, v58
    v_cvt_pk_bf16_f32 v67, v47, v46
    v_cvt_pk_bf16_f32 v66, v51, v50
    v_cvt_pk_bf16_f32 v65, v55, v54
    ds_write_b128 v106, v[64:67]
    v_mov_b32 v11, 12
    ds_write_b32 v10, v11
Sy12:
    ds_read_b32 v9, v19
    ds_read2st64_b32 v[36:37], v116 offset0:0 offset1:1
    ds_read2st64_b32 v[38:39], v116 offset0:2 offset1:3
    ds_read2st64_b32 v[40:41], v117 offset0:0 offset1:1
    ds_read2st64_b32 v[42:43], v117 offset0:2 offset1:3
    s_add_u32 s51, s51, 1
    s_cmp_lt_u32 s51, 3200000
    s_cbranch_scc0 Sy12c
    s_waitcnt lgkmcnt(4)
    v_cmp_gt_u32 vcc, 12, v9
    s_nop 0
    s_cbranch_vccnz Sy12
Sy12c:
    s_waitcnt lgkmcnt(2)
    v_mfma_f32_16x16x32_bf16 v[44:47], v[36:39], v[84:87], 0
    v_mfma_f32_16x16x32_bf16 v[48:51], v[36:39], v[88:91], 0
    s_waitcnt lgkmcnt(0)
    v_mfma_f32_16x16x32_bf16 v[44:47], v[40:43], v[84:87], v[44:47]
    v_mfma_f32_16x16x32_bf16 v[48:51], v[40:43], v[88:91], v[48:51]
    v_mfma_f32_16x16x32_bf16 v[52:55], v[36:39], a[112:115], 0
    v_mfma_f32_16x16x32_bf16 v[56:59], v[36:39], a[116:119], 0
    v_mfma_f32_16x16x32_bf16 v[52:55], v[40:43], a[120:123], v[52:55]
    v_mfma_f32_16x16x32_bf16 v[56:59], v[40:43], a[124:127], v[56:59]
    s_nop 2
    v_pk_mul_f32 v[102:103], v[44:45], v[80:81]
    v_pk_mul_f32 v[104:105], v[46:47], v[82:83]
    v_pk_mul_f32 v[44:45], v[44:45], v[76:77] neg_lo:[1,0] neg_hi:[1,0]
    v_pk_mul_f32 v[46:47], v[46:47], v[78:79] neg_lo:[1,0] neg_hi:[1,0]
    v_pk_fma_f32 v[102:103], v[48:49], v[76:77], v[102:103]
    v_pk_fma_f32 v[44:45], v[48:49], v[80:81], v[44:45]
    v_pk_fma_f32 v[104:105], v[50:51], v[78:79], v[104:105]
    v_pk_fma_f32 v[46:47], v[50:51], v[82:83], v[46:47]
    v_cvt_pk_bf16_f32 v60, v102, v44
    v_cvt_pk_bf16_f32 v61, v103, v45
    v_cvt_pk_bf16_f32 v62, v104, v46
    v_cvt_pk_bf16_f32 v63, v105, v47
    s_nop 1
    v_mfma_f32_16x16x32_bf16 v[20:23], v[112:115], v[60:63], v[20:23]
    v_mfma_f32_16x16x32_bf16 v[28:31], v[108:111], v[60:63], v[28:31]
    v_pk_mul_f32 v[102:103], v[52:53], v[96:97]
    v_pk_mul_f32 v[104:105], v[54:55], v[98:99]
    v_pk_mul_f32 v[52:53], v[52:53], v[92:93] neg_lo:[1,0] neg_hi:[1,0]
    v_pk_mul_f32 v[54:55], v[54:55], v[94:95] neg_lo:[1,0] neg_hi:[1,0]
    v_pk_fma_f32 v[102:103], v[56:57], v[92:93], v[102:103]
    v_pk_fma_f32 v[52:53], v[56:57], v[96:97], v[52:53]
    v_pk_fma_f32 v[104:105], v[58:59], v[94:95], v[104:105]
    v_pk_fma_f32 v[54:55], v[58:59], v[98:99], v[54:55]
    v_cvt_pk_bf16_f32 v64, v102, v52
    v_cvt_pk_bf16_f32 v65, v103, v53
    v_cvt_pk_bf16_f32 v66, v104, v54
    v_cvt_pk_bf16_f32 v67, v105, v55
    s_nop 1
    v_mfma_f32_16x16x32_bf16 v[24:27], v[112:115], v[64:67], v[24:27]
    v_mfma_f32_16x16x32_bf16 v[32:35], v[108:111], v[64:67], v[32:35]
    v_mov_b32 v11, 13
    ds_write_b32 v10, v11
    v_pk_add_f32 v[44:45], v[20:21], v[22:23]
    v_pk_mul_f32 v[46:47], v[20:21], v[20:21]
    v_pk_add_f32 v[48:49], v[28:29], v[30:31]
    v_pk_mul_f32 v[50:51], v[28:29], v[28:29]
    v_pk_fma_f32 v[46:47], v[22:23], v[22:23], v[46:47]
    v_pk_fma_f32 v[50:51], v[30:31], v[30:31], v[50:51]
    v_pk_add_f32 v[44:45], v[44:45], v[24:25]
    v_pk_fma_f32 v[46:47], v[24:25], v[24:25], v[46:47]
    v_pk_add_f32 v[48:49], v[48:49], v[32:33]
    v_pk_fma_f32 v[50:51], v[32:33], v[32:33], v[50:51]
    v_pk_add_f32 v[44:45], v[44:45], v[26:27]
    v_pk_fma_f32 v[46:47], v[26:27], v[26:27], v[46:47]
    v_pk_add_f32 v[48:49], v[48:49], v[34:35]
    v_pk_fma_f32 v[50:51], v[34:35], v[34:35], v[50:51]
    v_add_f32 v44, v44, v45
    v_add_f32 v48, v48, v49
    v_add_f32 v46, v46, v47
    v_add_f32 v50, v50, v51
    v_permlane32_swap_b32 v44, v48
    s_nop 0
    v_permlane32_swap_b32 v46, v50
    v_add_f32 v44, v44, v48
    v_add_f32 v46, v46, v50
    s_nop 0
    v_add_f32_dpp v44, v44, v44 row_ror:8 row_mask:0xf bank_mask:0xf
    v_add_f32_dpp v46, v46, v46 row_ror:8 row_mask:0xf bank_mask:0xf
    s_nop 0
    v_add_f32_dpp v44, v44, v44 row_ror:4 row_mask:0xf bank_mask:0xf
    v_add_f32_dpp v46, v46, v46 row_ror:4 row_mask:0xf bank_mask:0xf
    s_nop 0
    v_add_f32_dpp v44, v44, v44 row_ror:2 row_mask:0xf bank_mask:0xf
    v_add_f32_dpp v46, v46, v46 row_ror:2 row_mask:0xf bank_mask:0xf
    s_nop 0
    v_add_f32_dpp v44, v44, v44 row_ror:1 row_mask:0xf bank_mask:0xf
    v_add_f32_dpp v46, v46, v46 row_ror:1 row_mask:0xf bank_mask:0xf
    s_nop 0
    v_add_f32_dpp v44, v44, v44 row_bcast:15 row_mask:0xa bank_mask:0xf
    v_add_f32_dpp v46, v46, v46 row_bcast:15 row_mask:0xa bank_mask:0xf
    v_mul_f32 v44, 0x3b000000, v44
    v_mul_f32 v46, 0x3b000000, v46
    v_fma_f32 v46, -v44, v44, v46
    v_max_f32 v46, 0, v46
    v_add_f32 v46, 0x3727c5ac, v46
    v_rsq_f32 v46, v46
    s_nop 0
    v_mul_f32 v46, 0x3eeff558, v46
    v_mul_f32 v44, -v44, v46
    v_readlane_b32 s68, v46, 31
    v_readlane_b32 s69, v44, 31
    v_readlane_b32 s70, v46, 63
    v_readlane_b32 s71, v44, 63
    v_pk_fma_f32 v[60:61], v[20:21], s[68:69], s[68:69] op_sel:[0,0,1] op_sel_hi:[1,0,1]
    v_pk_fma_f32 v[62:63], v[22:23], s[68:69], s[68:69] op_sel:[0,0,1] op_sel_hi:[1,0,1]
    v_pk_fma_f32 v[64:65], v[24:25], s[68:69], s[68:69] op_sel:[0,0,1] op_sel_hi:[1,0,1]
    v_pk_fma_f32 v[66:67], v[26:27], s[68:69], s[68:69] op_sel:[0,0,1] op_sel_hi:[1,0,1]
    v_pk_fma_f32 v[68:69], v[28:29], s[70:71], s[70:71] op_sel:[0,0,1] op_sel_hi:[1,0,1]
    v_pk_fma_f32 v[70:71], v[30:31], s[70:71], s[70:71] op_sel:[0,0,1] op_sel_hi:[1,0,1]
    v_pk_fma_f32 v[72:73], v[32:33], s[70:71], s[70:71] op_sel:[0,0,1] op_sel_hi:[1,0,1]
    v_pk_fma_f32 v[74:75], v[34:35], s[70:71], s[70:71] op_sel:[0,0,1] op_sel_hi:[1,0,1]
    v_cvt_pk_bf16_f32 v36, v60, v64
    v_cvt_pk_bf16_f32 v37, v61, v65
    v_cvt_pk_bf16_f32 v38, v62, v66
    v_cvt_pk_bf16_f32 v39, v63, v67
    ds_write_b128 v118, v[36:39]
    v_cvt_pk_bf16_f32 v40, v68, v72
    v_cvt_pk_bf16_f32 v41, v69, v73
    v_cvt_pk_bf16_f32 v42, v70, v74
    v_cvt_pk_bf16_f32 v43, v71, v75
    ds_write_b128 v119, v[40:43]
    v_mov_b32 v11, 14
    ds_write_b32 v10, v11
Sy14:
    ds_read_b32 v9, v19
    ds_read_b128 v[44:47], v107 offset:0
    ds_read_b128 v[48:51], v107 offset:1024
    s_add_u32 s51, s51, 1
    s_cmp_lt_u32 s51, 3200000
    s_cbranch_scc0 Sy14c
    s_waitcnt lgkmcnt(2)
    v_cmp_gt_u32 vcc, 14, v9
    s_nop 0
    s_cbranch_vccnz Sy14
Sy14c:
    s_waitcnt lgkmcnt(1)
    buffer_store_dwordx4 v[44:47], v2, s[28:31], s63 offen offset:0 sc1
    s_waitcnt lgkmcnt(0)
    buffer_store_dwordx4 v[48:51], v2, s[28:31], s63 offen offset:1024 sc1
    v_mov_b32 v11, 15
    ds_write_b32 v10, v11
    s_mov_b32 s68, 0x16800000
    v_pk_mul_f32 v[20:21], v[20:21], s[68:69] op_sel_hi:[1,0]
    v_pk_mul_f32 v[22:23], v[22:23], s[68:69] op_sel_hi:[1,0]
    v_pk_mul_f32 v[24:25], v[24:25], s[68:69] op_sel_hi:[1,0]
    v_pk_mul_f32 v[26:27], v[26:27], s[68:69] op_sel_hi:[1,0]
    v_pk_mul_f32 v[28:29], v[28:29], s[68:69] op_sel_hi:[1,0]
    v_pk_mul_f32 v[30:31], v[30:31], s[68:69] op_sel_hi:[1,0]
    v_pk_mul_f32 v[32:33], v[32:33], s[68:69] op_sel_hi:[1,0]
    v_pk_mul_f32 v[34:35], v[34:35], s[68:69] op_sel_hi:[1,0]
    v_cvt_pk_bf16_f32 v60, v20, v24
    v_cvt_pk_bf16_f32 v61, v21, v25
    v_cvt_pk_bf16_f32 v62, v22, v26
    v_cvt_pk_bf16_f32 v63, v23, v27
    v_bfi_b32 v60, v3, s57, v60
    v_bfi_b32 v61, v3, s57, v61
    v_bfi_b32 v62, v3, s57, v62
    v_bfi_b32 v63, v3, s57, v63
    ds_write2st64_b32 v120, v60, v61 offset0:0 offset1:1
    ds_write2st64_b32 v120, v62, v63 offset0:2 offset1:3
    v_cvt_pk_bf16_f32 v64, v28, v32
    v_cvt_pk_bf16_f32 v65, v29, v33
    v_cvt_pk_bf16_f32 v66, v30, v34
    v_cvt_pk_bf16_f32 v67, v31, v35
    v_bfi_b32 v64, v3, s57, v64
    v_bfi_b32 v65, v3, s57, v65
    v_bfi_b32 v66, v3, s57, v66
    v_bfi_b32 v67, v3, s57, v67
    ds_write2st64_b32 v120, v64, v65 offset0:4 offset1:5
    ds_write2st64_b32 v120, v66, v67 offset0:6 offset1:7
    ds_read_b128 a[0:3], v121 offset:0
    ds_read_b128 a[4:7], v121 offset:1024
    s_waitcnt lgkmcnt(0)
    s_or_b32 s47, s2, s45
    s_cmp_lg_u32 s47, 0
    s_cbranch_scc1 Lnon
    v_mov_b32 v7, s57
    s_mov_b32 s47, 524288
    buffer_store_dword v7, off, s[28:31], s47 sc1
Lnon:
    v_and_b32 v6, 1, v5
    v_bfe_u32 v7, v1, 3, 1
    v_lshl_add_u32 v7, v6, 1, v7
    v_bfe_u32 v8, v1, 2, 2
    v_lshlrev_b32 v6, 10, v5
    v_lshl_add_u32 v6, v8, 7, v6
    v_and_b32 v8, 3, v1
    v_lshl_add_u32 v6, v8, 3, v6
    s_add_u32 s47, s58, 0
    s_and_b32 s47, s47, 3
    v_xor_b32 v8, s47, v7
    v_lshl_add_u32 v16, v8, 5, v6
    s_add_u32 s47, s58, 1
    s_and_b32 s47, s47, 3
    v_xor_b32 v8, s47, v7
    v_lshl_add_u32 v17, v8, 5, v6
    s_add_u32 s47, s58, 2
    s_and_b32 s47, s47, 3
    v_xor_b32 v8, s47, v7
    v_lshl_add_u32 v18, v8, 5, v6
    s_add_u32 s47, s58, 3
    s_and_b32 s47, s47, 3
    v_xor_b32 v8, s47, v7
    v_lshl_add_u32 v19, v8, 5, v6
    v_bfe_u32 v6, v1, 3, 1
    v_mul_u32_u24 v6, 8320, v6
    v_and_b32 v8, 7, v1
    v_lshl_add_u32 v12, v5, 7, v6
    v_lshl_add_u32 v12, v8, 4, v12
    v_lshrrev_b32 v6, 1, v5
    v_mul_u32_u24 v6, 6144, v6
    v_lshl_add_u32 v6, v5, 9, v6
    v_lshl_add_u32 v13, v4, 4, v6
    s_mul_i32 s47, s60, 33280
    s_add_u32 s68, s47, 11534336
    s_add_u32 s69, s47, 11538432
    s_add_u32 s70, s47, 11550976
    s_add_u32 s71, s47, 11555072
    s_mul_i32 s48, s60, 112
    s_add_u32 s48, s48, s59
    s_add_u32 s47, s58, 0
    s_and_b32 s47, s47, 3
    s_add_u32 s47, s47, s48
    s_lshl_b32 s47, s47, 10
    s_add_u32 s72, s47, 16777216
    s_add_u32 s47, s58, 1
    s_and_b32 s47, s47, 3
    s_add_u32 s47, s47, s48
    s_lshl_b32 s47, s47, 10
    s_add_u32 s73, s47, 16777216
    s_add_u32 s47, s58, 2
    s_and_b32 s47, s47, 3
    s_add_u32 s47, s47, s48
    s_lshl_b32 s47, s47, 10
    s_add_u32 s74, s47, 16777216
    s_add_u32 s47, s58, 3
    s_and_b32 s47, s47, 3
    s_add_u32 s47, s47, s48
    s_lshl_b32 s47, s47, 10
    s_add_u32 s75, s47, 16777216
    s_mov_b32 s76, 0x409d30fc
    s_mov_b32 s77, 0x6760ec05
    v_mov_b32 v0, v10
    v_and_b32 v6, 7, v1
    v_lshrrev_b32 v7, 3, v1
    v_lshlrev_b32 v20, 1, v6
    v_xor_b32 v20, v20, v7
    v_lshlrev_b32 v20, 4, v20
    v_lshl_add_u32 v20, v7, 8, v20
    s_lshl_b32 s49, s45, 11
    s_add_u32 s49, s49, 0x10000
    v_add_u32 v20, s49, v20
    v_xor_b32 v21, 16, v20
    v_lshlrev_b32 v6, 4, v6
    v_lshl_add_u32 v22, v7, 10, v6
    v_lshl_add_u32 v23, v7, 18, v6
    v_and_b32 v15, 3, v1
    v_lshlrev_b32 v15, 2, v15
    v_add_u32 v15, 157712, v15
    s_lshl_b32 s47, s62, 7
    s_lshl_b32 s48, s61, 2
    s_sub_u32 s48, s48, s66
    s_add_u32 s48, s48, 1
    s_lshl_b32 s48, s48, 2
    s_add_u32 s48, s48, s45
    s_lshl_b32 s78, s48, 13
    s_add_u32 s78, s78, s47
    s_add_u32 s78, s78, 14680064
    s_add_u32 s79, s78, 65536
    s_lshl_b32 s80, s48, 10
    s_add_u32 s80, s80, s47
    s_add_u32 s81, s80, 8192
    s_lshl_b32 s82, s56, 29
    s_sub_u32 s82, 0x68800000, s82
    s_mul_i32 s86, s56, -64
    s_lshl_b32 s47, s2, 13
    s_lshl_b32 s48, s45, 11
    s_add_u32 s47, s47, s48
    s_add_u32 s84, s47, 27262976
    s_xor_b32 s85, s84, 8192
    s_waitcnt vmcnt(0)
    s_barrier
    s_setprio 3
    buffer_load_dwordx4 v[88:91], v12, s[28:31], s68 offen offset:0 sc1
    buffer_load_dwordx4 v[92:95], v12, s[28:31], s70 offen offset:0 sc1
    buffer_load_dwordx4 v[96:99], v12, s[28:31], s68 offen offset:512 sc1
    buffer_load_dwordx4 v[100:103], v12, s[28:31], s70 offen offset:512 sc1
FSTART:
    ds_read_b64_tr_b16 a[112:113], v16 offset:0
    ds_read_b64_tr_b16 a[114:115], v16 offset:512
    ds_read_b64_tr_b16 a[116:117], v18 offset:32768
    ds_read_b64_tr_b16 a[118:119], v18 offset:33280
    ds_read_b64_tr_b16 a[120:121], v17 offset:0
    ds_read_b64_tr_b16 a[122:123], v17 offset:512
    s_waitcnt vmcnt(2)
    v_max_u32 v14, v95, v91
    v_cmp_eq_u32 vcc, -1, v14
    s_nop 0
    s_cbranch_vccnz R_G1F0
C_G1F0:
    v_mov_b32 v6, 17
    ds_write_b32 v0, v6
    s_waitcnt lgkmcnt(5)
    v_mfma_f32_16x16x32_bf16 v[24:27], a[112:115], v[88:91], 0
    ds_read_b64_tr_b16 a[124:125], v19 offset:32768
    buffer_load_dwordx4 v[104:107], v12, s[28:31], s68 offen offset:1024 sc1
    v_mfma_f32_16x16x32_bf16 v[28:31], a[112:115], v[92:95], 0
    ds_read_b64_tr_b16 a[126:127], v19 offset:33280
    s_waitcnt lgkmcnt(5)
    v_mfma_f32_16x16x32_bf16 v[32:35], a[116:119], v[88:91], 0
    ds_read_b64_tr_b16 a[112:113], v18 offset:0
    buffer_load_dwordx4 v[108:111], v12, s[28:31], s70 offen offset:1024 sc1
    v_mfma_f32_16x16x32_bf16 v[36:39], a[116:119], v[92:95], 0
    ds_read_b64_tr_b16 a[114:115], v18 offset:512
    s_waitcnt lgkmcnt(5)
    v_mfma_f32_16x16x32_bf16 v[40:43], a[120:123], v[88:91], 0
    ds_read_b64_tr_b16 a[116:117], v16 offset:32768
    buffer_load_dwordx4 v[112:115], v12, s[28:31], s68 offen offset:1536 sc1
    v_mfma_f32_16x16x32_bf16 v[44:47], a[120:123], v[92:95], 0
    ds_read_b64_tr_b16 a[118:119], v16 offset:33280
    s_waitcnt lgkmcnt(4)
    v_mfma_f32_16x16x32_bf16 v[48:51], a[124:127], v[88:91], 0
    ds_read_b64_tr_b16 a[120:121], v19 offset:0
    buffer_load_dwordx4 v[116:119], v12, s[28:31], s70 offen offset:1536 sc1
    v_mfma_f32_16x16x32_bf16 v[52:55], a[124:127], v[92:95], 0
    ds_read_b64_tr_b16 a[122:123], v19 offset:512
    s_waitcnt lgkmcnt(4)
    v_mfma_f32_16x16x32_bf16 v[56:59], a[112:115], v[88:91], 0
    ds_read_b64_tr_b16 a[124:125], v17 offset:32768
    v_mfma_f32_16x16x32_bf16 v[60:63], a[112:115], v[92:95], 0
    ds_read_b64_tr_b16 a[126:127], v17 offset:33280
    s_waitcnt vmcnt(4) lgkmcnt(4)
    v_mfma_f32_16x16x32_bf16 v[64:67], a[116:119], v[88:91], 0
    ds_read_b64_tr_b16 a[112:113], v16 offset:4096
    v_max_u32 v14, v103, v99
    v_mfma_f32_16x16x32_bf16 v[68:71], a[116:119], v[92:95], 0
    ds_read_b64_tr_b16 a[114:115], v16 offset:4608
    s_waitcnt lgkmcnt(4)
    v_mfma_f32_16x16x32_bf16 v[72:75], a[120:123], v[88:91], 0
    ds_read_b64_tr_b16 a[116:117], v18 offset:36864
    v_cmp_eq_u32 vcc, -1, v14
    v_mfma_f32_16x16x32_bf16 v[76:79], a[120:123], v[92:95], 0
    ds_read_b64_tr_b16 a[118:119], v18 offset:37376
    s_waitcnt lgkmcnt(4)
    v_mfma_f32_16x16x32_bf16 v[80:83], a[124:127], v[88:91], 0
    ds_read_b64_tr_b16 a[120:121], v17 offset:4096
    s_cbranch_vccnz R_G1F1
C_G1F1:
    v_mfma_f32_16x16x32_bf16 v[84:87], a[124:127], v[92:95], 0
    ds_read_b64_tr_b16 a[122:123], v17 offset:4608
    s_waitcnt lgkmcnt(4)
    v_mfma_f32_16x16x32_bf16 v[24:27], a[112:115], v[96:99], v[24:27]
    ds_read_b64_tr_b16 a[124:125], v19 offset:36864
    buffer_load_dwordx4 v[120:123], v12, s[28:31], s68 offen offset:2048 sc1
    v_mfma_f32_16x16x32_bf16 v[28:31], a[112:115], v[100:103], v[28:31]
    ds_read_b64_tr_b16 a[126:127], v19 offset:37376
    s_waitcnt lgkmcnt(4)
    v_mfma_f32_16x16x32_bf16 v[32:35], a[116:119], v[96:99], v[32:35]
    ds_read_b64_tr_b16 a[112:113], v18 offset:4096
    buffer_load_dwordx4 v[124:127], v12, s[28:31], s70 offen offset:2048 sc1
    v_mfma_f32_16x16x32_bf16 v[36:39], a[116:119], v[100:103], v[36:39]
    ds_read_b64_tr_b16 a[114:115], v18 offset:4608
    s_waitcnt lgkmcnt(4)
    v_mfma_f32_16x16x32_bf16 v[40:43], a[120:123], v[96:99], v[40:43]
    ds_read_b64_tr_b16 a[116:117], v16 offset:36864
    buffer_load_dwordx4 v[88:91], v12, s[28:31], s68 offen offset:2560 sc1
    v_mfma_f32_16x16x32_bf16 v[44:47], a[120:123], v[100:103], v[44:47]
    ds_read_b64_tr_b16 a[118:119], v16 offset:37376
    s_waitcnt lgkmcnt(4)
    v_mfma_f32_16x16x32_bf16 v[48:51], a[124:127], v[96:99], v[48:51]
    ds_read_b64_tr_b16 a[120:121], v19 offset:4096
    buffer_load_dwordx4 v[92:95], v12, s[28:31], s70 offen offset:2560 sc1
    v_mfma_f32_16x16x32_bf16 v[52:55], a[124:127], v[100:103], v[52:55]
    ds_read_b64_tr_b16 a[122:123], v19 offset:4608
    s_waitcnt lgkmcnt(4)
    v_mfma_f32_16x16x32_bf16 v[56:59], a[112:115], v[96:99], v[56:59]
    ds_read_b64_tr_b16 a[124:125], v17 offset:36864
    v_mfma_f32_16x16x32_bf16 v[60:63], a[112:115], v[100:103], v[60:63]
    ds_read_b64_tr_b16 a[126:127], v17 offset:37376
    s_waitcnt vmcnt(6) lgkmcnt(4)
    v_mfma_f32_16x16x32_bf16 v[64:67], a[116:119], v[96:99], v[64:67]
    ds_read_b64_tr_b16 a[112:113], v16 offset:8192
    v_max_u32 v14, v111, v107
    v_mfma_f32_16x16x32_bf16 v[68:71], a[116:119], v[100:103], v[68:71]
    ds_read_b64_tr_b16 a[114:115], v16 offset:8704
    s_waitcnt lgkmcnt(4)
    v_mfma_f32_16x16x32_bf16 v[72:75], a[120:123], v[96:99], v[72:75]
    ds_read_b64_tr_b16 a[116:117], v18 offset:40960
    v_cmp_eq_u32 vcc, -1, v14
    v_mfma_f32_16x16x32_bf16 v[76:79], a[120:123], v[100:103], v[76:79]
    ds_read_b64_tr_b16 a[118:119], v18 offset:41472
    s_waitcnt lgkmcnt(4)
    v_mfma_f32_16x16x32_bf16 v[80:83], a[124:127], v[96:99], v[80:83]
    ds_read_b64_tr_b16 a[120:121], v17 offset:8192
    s_cbranch_vccnz R_G1F2
C_G1F2:
    v_mfma_f32_16x16x32_bf16 v[84:87], a[124:127], v[100:103], v[84:87]
    ds_read_b64_tr_b16 a[122:123], v17 offset:8704
    s_waitcnt lgkmcnt(4)
    v_mfma_f32_16x16x32_bf16 v[24:27], a[112:115], v[104:107], v[24:27]
    ds_read_b64_tr_b16 a[124:125], v19 offset:40960
    buffer_load_dwordx4 v[96:99], v12, s[28:31], s68 offen offset:3072 sc1
    v_mfma_f32_16x16x32_bf16 v[28:31], a[112:115], v[108:111], v[28:31]
    ds_read_b64_tr_b16 a[126:127], v19 offset:41472
    s_waitcnt lgkmcnt(4)
    v_mfma_f32_16x16x32_bf16 v[32:35], a[116:119], v[104:107], v[32:35]
    ds_read_b64_tr_b16 a[112:113], v18 offset:8192
    buffer_load_dwordx4 v[100:103], v12, s[28:31], s70 offen offset:3072 sc1
    v_mfma_f32_16x16x32_bf16 v[36:39], a[116:119], v[108:111], v[36:39]
    ds_read_b64_tr_b16 a[114:115], v18 offset:8704
    s_waitcnt lgkmcnt(4)
    v_mfma_f32_16x16x32_bf16 v[40:43], a[120:123], v[104:107], v[40:43]
    ds_read_b64_tr_b16 a[116:117], v16 offset:40960
    v_mfma_f32_16x16x32_bf16 v[44:47], a[120:123], v[108:111], v[44:47]
    ds_read_b64_tr_b16 a[118:119], v16 offset:41472
    s_waitcnt lgkmcnt(4)
    v_mfma_f32_16x16x32_bf16 v[48:51], a[124:127], v[104:107], v[48:51]
    ds_read_b64_tr_b16 a[120:121], v19 offset:8192
    v_mfma_f32_16x16x32_bf16 v[52:55], a[124:127], v[108:111], v[52:55]
    ds_read_b64_tr_b16 a[122:123], v19 offset:8704
    s_waitcnt lgkmcnt(4)
    v_mfma_f32_16x16x32_bf16 v[56:59], a[112:115], v[104:107], v[56:59]
    ds_read_b64_tr_b16 a[124:125], v17 offset:40960
    v_mfma_f32_16x16x32_bf16 v[60:63], a[112:115], v[108:111], v[60:63]
    ds_read_b64_tr_b16 a[126:127], v17 offset:41472
    s_waitcnt vmcnt(6) lgkmcnt(4)
    v_mfma_f32_16x16x32_bf16 v[64:67], a[116:119], v[104:107], v[64:67]
    ds_read_b64_tr_b16 a[112:113], v16 offset:12288
    v_max_u32 v14, v119, v115
    v_mfma_f32_16x16x32_bf16 v[68:71], a[116:119], v[108:111], v[68:71]
    ds_read_b64_tr_b16 a[114:115], v16 offset:12800
    s_waitcnt lgkmcnt(4)
    v_mfma_f32_16x16x32_bf16 v[72:75], a[120:123], v[104:107], v[72:75]
    ds_read_b64_tr_b16 a[116:117], v18 offset:45056
    v_cmp_eq_u32 vcc, -1, v14
    v_mfma_f32_16x16x32_bf16 v[76:79], a[120:123], v[108:111], v[76:79]
    ds_read_b64_tr_b16 a[118:119], v18 offset:45568
    s_waitcnt lgkmcnt(4)
    v_mfma_f32_16x16x32_bf16 v[80:83], a[124:127], v[104:107], v[80:83]
    ds_read_b64_tr_b16 a[120:121], v17 offset:12288
    s_cbranch_vccnz R_G1F3
C_G1F3:
    v_mfma_f32_16x16x32_bf16 v[84:87], a[124:127], v[108:111], v[84:87]
    ds_read_b64_tr_b16 a[122:123], v17 offset:12800
    s_waitcnt lgkmcnt(4)
    v_mfma_f32_16x16x32_bf16 v[24:27], a[112:115], v[112:115], v[24:27]
    ds_read_b64_tr_b16 a[124:125], v19 offset:45056
    buffer_load_dwordx4 v[104:107], v12, s[28:31], s68 offen offset:3584 sc1
    v_mfma_f32_16x16x32_bf16 v[28:31], a[112:115], v[116:119], v[28:31]
    ds_read_b64_tr_b16 a[126:127], v19 offset:45568
    s_waitcnt lgkmcnt(4)
    v_mfma_f32_16x16x32_bf16 v[32:35], a[116:119], v[112:115], v[32:35]
    ds_read_b64_tr_b16 a[112:113], v18 offset:12288
    buffer_load_dwordx4 v[108:111], v12, s[28:31], s70 offen offset:3584 sc1
    v_mfma_f32_16x16x32_bf16 v[36:39], a[116:119], v[116:119], v[36:39]
    ds_read_b64_tr_b16 a[114:115], v18 offset:12800
    s_waitcnt lgkmcnt(4)
    v_mfma_f32_16x16x32_bf16 v[40:43], a[120:123], v[112:115], v[40:43]
    ds_read_b64_tr_b16 a[116:117], v16 offset:45056
    v_mfma_f32_16x16x32_bf16 v[44:47], a[120:123], v[116:119], v[44:47]
    ds_read_b64_tr_b16 a[118:119], v16 offset:45568
    s_waitcnt lgkmcnt(4)
    v_mfma_f32_16x16x32_bf16 v[48:51], a[124:127], v[112:115], v[48:51]
    ds_read_b64_tr_b16 a[120:121], v19 offset:12288
    v_mfma_f32_16x16x32_bf16 v[52:55], a[124:127], v[116:119], v[52:55]
    ds_read_b64_tr_b16 a[122:123], v19 offset:12800
    s_waitcnt lgkmcnt(4)
    v_mfma_f32_16x16x32_bf16 v[56:59], a[112:115], v[112:115], v[56:59]
    ds_read_b64_tr_b16 a[124:125], v17 offset:45056
    v_mfma_f32_16x16x32_bf16 v[60:63], a[112:115], v[116:119], v[60:63]
    ds_read_b64_tr_b16 a[126:127], v17 offset:45568
    s_waitcnt vmcnt(6) lgkmcnt(4)
    v_mfma_f32_16x16x32_bf16 v[64:67], a[116:119], v[112:115], v[64:67]
    ds_read_b64_tr_b16 a[112:113], v16 offset:16384
    v_max_u32 v14, v127, v123
    v_mfma_f32_16x16x32_bf16 v[68:71], a[116:119], v[116:119], v[68:71]
    ds_read_b64_tr_b16 a[114:115], v16 offset:16896
    s_waitcnt lgkmcnt(4)
    v_mfma_f32_16x16x32_bf16 v[72:75], a[120:123], v[112:115], v[72:75]
    ds_read_b64_tr_b16 a[116:117], v18 offset:49152
    v_cmp_eq_u32 vcc, -1, v14
    v_mfma_f32_16x16x32_bf16 v[76:79], a[120:123], v[116:119], v[76:79]
    ds_read_b64_tr_b16 a[118:119], v18 offset:49664
    s_waitcnt lgkmcnt(4)
    v_mfma_f32_16x16x32_bf16 v[80:83], a[124:127], v[112:115], v[80:83]
    ds_read_b64_tr_b16 a[120:121], v17 offset:16384
    s_cbranch_vccnz R_G1F4
C_G1F4:
    v_mfma_f32_16x16x32_bf16 v[84:87], a[124:127], v[116:119], v[84:87]
    ds_read_b64_tr_b16 a[122:123], v17 offset:16896
    s_waitcnt lgkmcnt(4)
    v_mfma_f32_16x16x32_bf16 v[24:27], a[112:115], v[120:123], v[24:27]
    ds_read_b64_tr_b16 a[124:125], v19 offset:49152
    buffer_load_dwordx4 v[112:115], v12, s[28:31], s69 offen offset:0 sc1
    v_mfma_f32_16x16x32_bf16 v[28:31], a[112:115], v[124:127], v[28:31]
    ds_read_b64_tr_b16 a[126:127], v19 offset:49664
    s_waitcnt lgkmcnt(4)
    v_mfma_f32_16x16x32_bf16 v[32:35], a[116:119], v[120:123], v[32:35]
    ds_read_b64_tr_b16 a[112:113], v18 offset:16384
    buffer_load_dwordx4 v[116:119], v12, s[28:31], s71 offen offset:0 sc1
    v_mfma_f32_16x16x32_bf16 v[36:39], a[116:119], v[124:127], v[36:39]
    ds_read_b64_tr_b16 a[114:115], v18 offset:16896
    s_waitcnt lgkmcnt(4)
    v_mfma_f32_16x16x32_bf16 v[40:43], a[120:123], v[120:123], v[40:43]
    ds_read_b64_tr_b16 a[116:117], v16 offset:49152
    v_mfma_f32_16x16x32_bf16 v[44:47], a[120:123], v[124:127], v[44:47]
    ds_read_b64_tr_b16 a[118:119], v16 offset:49664
    s_waitcnt lgkmcnt(4)
    v_mfma_f32_16x16x32_bf16 v[48:51], a[124:127], v[120:123], v[48:51]
    ds_read_b64_tr_b16 a[120:121], v19 offset:16384
    v_mfma_f32_16x16x32_bf16 v[52:55], a[124:127], v[124:127], v[52:55]
    ds_read_b64_tr_b16 a[122:123], v19 offset:16896
    s_waitcnt lgkmcnt(4)
    v_mfma_f32_16x16x32_bf16 v[56:59], a[112:115], v[120:123], v[56:59]
    ds_read_b64_tr_b16 a[124:125], v17 offset:49152
    v_mfma_f32_16x16x32_bf16 v[60:63], a[112:115], v[124:127], v[60:63]
    ds_read_b64_tr_b16 a[126:127], v17 offset:49664
    s_waitcnt vmcnt(6) lgkmcnt(4)
    v_mfma_f32_16x16x32_bf16 v[64:67], a[116:119], v[120:123], v[64:67]
    ds_read_b64_tr_b16 a[112:113], v16 offset:20480
    v_max_u32 v14, v95, v91
    v_mfma_f32_16x16x32_bf16 v[68:71], a[116:119], v[124:127], v[68:71]
    ds_read_b64_tr_b16 a[114:115], v16 offset:20992
    s_waitcnt lgkmcnt(4)
    v_mfma_f32_16x16x32_bf16 v[72:75], a[120:123], v[120:123], v[72:75]
    ds_read_b64_tr_b16 a[116:117], v18 offset:53248
    v_cmp_eq_u32 vcc, -1, v14
    v_mfma_f32_16x16x32_bf16 v[76:79], a[120:123], v[124:127], v[76:79]
    ds_read_b64_tr_b16 a[118:119], v18 offset:53760
    s_waitcnt lgkmcnt(4)
    v_mfma_f32_16x16x32_bf16 v[80:83], a[124:127], v[120:123], v[80:83]
    ds_read_b64_tr_b16 a[120:121], v17 offset:20480
    s_cbranch_vccnz R_G1F5
C_G1F5:
    v_mfma_f32_16x16x32_bf16 v[84:87], a[124:127], v[124:127], v[84:87]
    ds_read_b64_tr_b16 a[122:123], v17 offset:20992
    s_waitcnt lgkmcnt(4)
    v_mfma_f32_16x16x32_bf16 v[24:27], a[112:115], v[88:91], v[24:27]
    ds_read_b64_tr_b16 a[124:125], v19 offset:53248
    buffer_load_dwordx4 v[120:123], v12, s[28:31], s69 offen offset:512 sc1
    v_mfma_f32_16x16x32_bf16 v[28:31], a[112:115], v[92:95], v[28:31]
    ds_read_b64_tr_b16 a[126:127], v19 offset:53760
    s_waitcnt lgkmcnt(4)
    v_mfma_f32_16x16x32_bf16 v[32:35], a[116:119], v[88:91], v[32:35]
    ds_read_b64_tr_b16 a[112:113], v18 offset:20480
    buffer_load_dwordx4 v[124:127], v12, s[28:31], s71 offen offset:512 sc1
    v_mfma_f32_16x16x32_bf16 v[36:39], a[116:119], v[92:95], v[36:39]
    ds_read_b64_tr_b16 a[114:115], v18 offset:20992
    s_waitcnt lgkmcnt(4)
    v_mfma_f32_16x16x32_bf16 v[40:43], a[120:123], v[88:91], v[40:43]
    ds_read_b64_tr_b16 a[116:117], v16 offset:53248
    v_mfma_f32_16x16x32_bf16 v[44:47], a[120:123], v[92:95], v[44:47]
    ds_read_b64_tr_b16 a[118:119], v16 offset:53760
    s_waitcnt lgkmcnt(4)
    v_mfma_f32_16x16x32_bf16 v[48:51], a[124:127], v[88:91], v[48:51]
    ds_read_b64_tr_b16 a[120:121], v19 offset:20480
    v_mfma_f32_16x16x32_bf16 v[52:55], a[124:127], v[92:95], v[52:55]
    ds_read_b64_tr_b16 a[122:123], v19 offset:20992
    s_waitcnt lgkmcnt(4)
    v_mfma_f32_16x16x32_bf16 v[56:59], a[112:115], v[88:91], v[56:59]
    ds_read_b64_tr_b16 a[124:125], v17 offset:53248
    v_mfma_f32_16x16x32_bf16 v[60:63], a[112:115], v[92:95], v[60:63]
    ds_read_b64_tr_b16 a[126:127], v17 offset:53760
    s_waitcnt vmcnt(6) lgkmcnt(4)
    v_mfma_f32_16x16x32_bf16 v[64:67], a[116:119], v[88:91], v[64:67]
    ds_read_b64_tr_b16 a[112:113], v16 offset:24576
    v_max_u32 v14, v103, v99
    v_mfma_f32_16x16x32_bf16 v[68:71], a[116:119], v[92:95], v[68:71]
    ds_read_b64_tr_b16 a[114:115], v16 offset:25088
    s_waitcnt lgkmcnt(4)
    v_mfma_f32_16x16x32_bf16 v[72:75], a[120:123], v[88:91], v[72:75]
    ds_read_b64_tr_b16 a[116:117], v18 offset:57344
    v_cmp_eq_u32 vcc, -1, v14
    v_mfma_f32_16x16x32_bf16 v[76:79], a[120:123], v[92:95], v[76:79]
    ds_read_b64_tr_b16 a[118:119], v18 offset:57856
    s_waitcnt lgkmcnt(4)
    v_mfma_f32_16x16x32_bf16 v[80:83], a[124:127], v[88:91], v[80:83]
    ds_read_b64_tr_b16 a[120:121], v17 offset:24576
    s_cbranch_vccnz R_G1F6
C_G1F6:
    v_mfma_f32_16x16x32_bf16 v[84:87], a[124:127], v[92:95], v[84:87]
    ds_read_b64_tr_b16 a[122:123], v17 offset:25088
    s_waitcnt lgkmcnt(4)
    v_mfma_f32_16x16x32_bf16 v[24:27], a[112:115], v[96:99], v[24:27]
    ds_read_b64_tr_b16 a[124:125], v19 offset:57344
    buffer_load_dwordx4 v[88:91], v12, s[28:31], s69 offen offset:1024 sc1
    v_mfma_f32_16x16x32_bf16 v[28:31], a[112:115], v[100:103], v[28:31]
    ds_read_b64_tr_b16 a[126:127], v19 offset:57856
    s_waitcnt lgkmcnt(4)
    v_mfma_f32_16x16x32_bf16 v[32:35], a[116:119], v[96:99], v[32:35]
    ds_read_b64_tr_b16 a[112:113], v18 offset:24576
    buffer_load_dwordx4 v[92:95], v12, s[28:31], s71 offen offset:1024 sc1
    v_mfma_f32_16x16x32_bf16 v[36:39], a[116:119], v[100:103], v[36:39]
    ds_read_b64_tr_b16 a[114:115], v18 offset:25088
    s_waitcnt lgkmcnt(4)
    v_mfma_f32_16x16x32_bf16 v[40:43], a[120:123], v[96:99], v[40:43]
    ds_read_b64_tr_b16 a[116:117], v16 offset:57344
    v_mfma_f32_16x16x32_bf16 v[44:47], a[120:123], v[100:103], v[44:47]
    ds_read_b64_tr_b16 a[118:119], v16 offset:57856
    s_waitcnt lgkmcnt(4)
    v_mfma_f32_16x16x32_bf16 v[48:51], a[124:127], v[96:99], v[48:51]
    ds_read_b64_tr_b16 a[120:121], v19 offset:24576
    v_mfma_f32_16x16x32_bf16 v[52:55], a[124:127], v[100:103], v[52:55]
    ds_read_b64_tr_b16 a[122:123], v19 offset:25088
    s_waitcnt lgkmcnt(4)
    v_mfma_f32_16x16x32_bf16 v[56:59], a[112:115], v[96:99], v[56:59]
    ds_read_b64_tr_b16 a[124:125], v17 offset:57344
    v_mfma_f32_16x16x32_bf16 v[60:63], a[112:115], v[100:103], v[60:63]
    ds_read_b64_tr_b16 a[126:127], v17 offset:57856
    s_waitcnt vmcnt(6) lgkmcnt(4)
    v_mfma_f32_16x16x32_bf16 v[64:67], a[116:119], v[96:99], v[64:67]
    ds_read_b64_tr_b16 a[112:113], v16 offset:28672
    v_max_u32 v14, v111, v107
    v_mfma_f32_16x16x32_bf16 v[68:71], a[116:119], v[100:103], v[68:71]
    ds_read_b64_tr_b16 a[114:115], v16 offset:29184
    s_waitcnt lgkmcnt(4)
    v_mfma_f32_16x16x32_bf16 v[72:75], a[120:123], v[96:99], v[72:75]
    ds_read_b64_tr_b16 a[116:117], v18 offset:61440
    v_cmp_eq_u32 vcc, -1, v14
    v_mfma_f32_16x16x32_bf16 v[76:79], a[120:123], v[100:103], v[76:79]
    ds_read_b64_tr_b16 a[118:119], v18 offset:61952
    s_waitcnt lgkmcnt(4)
    v_mfma_f32_16x16x32_bf16 v[80:83], a[124:127], v[96:99], v[80:83]
    ds_read_b64_tr_b16 a[120:121], v17 offset:28672
    s_cbranch_vccnz R_G1F7
C_G1F7:
    v_mfma_f32_16x16x32_bf16 v[84:87], a[124:127], v[100:103], v[84:87]
    ds_read_b64_tr_b16 a[122:123], v17 offset:29184
    s_waitcnt lgkmcnt(4)
    v_mfma_f32_16x16x32_bf16 v[24:27], a[112:115], v[104:107], v[24:27]
    ds_read_b64_tr_b16 a[124:125], v19 offset:61440
    buffer_load_dwordx4 v[96:99], v12, s[28:31], s69 offen offset:1536 sc1
    v_mfma_f32_16x16x32_bf16 v[28:31], a[112:115], v[108:111], v[28:31]
    ds_read_b64_tr_b16 a[126:127], v19 offset:61952
    s_waitcnt lgkmcnt(4)
    v_mfma_f32_16x16x32_bf16 v[32:35], a[116:119], v[104:107], v[32:35]
    ds_read_b64_tr_b16 a[112:113], v18 offset:28672
    buffer_load_dwordx4 v[100:103], v12, s[28:31], s71 offen offset:1536 sc1
    v_mfma_f32_16x16x32_bf16 v[36:39], a[116:119], v[108:111], v[36:39]
    ds_read_b64_tr_b16 a[114:115], v18 offset:29184
    s_waitcnt lgkmcnt(4)
    v_mfma_f32_16x16x32_bf16 v[40:43], a[120:123], v[104:107], v[40:43]
    ds_read_b64_tr_b16 a[116:117], v16 offset:61440
    v_mfma_f32_16x16x32_bf16 v[44:47], a[120:123], v[108:111], v[44:47]
    ds_read_b64_tr_b16 a[118:119], v16 offset:61952
    s_waitcnt lgkmcnt(4)
    v_mfma_f32_16x16x32_bf16 v[48:51], a[124:127], v[104:107], v[48:51]
    ds_read_b64_tr_b16 a[120:121], v19 offset:28672
    v_mfma_f32_16x16x32_bf16 v[52:55], a[124:127], v[108:111], v[52:55]
    ds_read_b64_tr_b16 a[122:123], v19 offset:29184
    s_waitcnt lgkmcnt(4)
    v_mfma_f32_16x16x32_bf16 v[56:59], a[112:115], v[104:107], v[56:59]
    ds_read_b64_tr_b16 a[124:125], v17 offset:61440
    v_mfma_f32_16x16x32_bf16 v[60:63], a[112:115], v[108:111], v[60:63]
    ds_read_b64_tr_b16 a[126:127], v17 offset:61952
    s_waitcnt vmcnt(6) lgkmcnt(4)
    v_mfma_f32_16x16x32_bf16 v[64:67], a[116:119], v[104:107], v[64:67]
    v_xor_b32 v16, 0x10000, v16
    ds_read_b64_tr_b16 a[112:113], v16 offset:0
    v_max_u32 v14, v119, v115
    v_mfma_f32_16x16x32_bf16 v[68:71], a[116:119], v[108:111], v[68:71]
    ds_read_b64_tr_b16 a[114:115], v16 offset:512
    s_waitcnt lgkmcnt(4)
    v_mfma_f32_16x16x32_bf16 v[72:75], a[120:123], v[104:107], v[72:75]
    v_xor_b32 v18, 0x10000, v18
    ds_read_b64_tr_b16 a[116:117], v18 offset:32768
    v_cmp_eq_u32 vcc, -1, v14
    v_mfma_f32_16x16x32_bf16 v[76:79], a[120:123], v[108:111], v[76:79]
    ds_read_b64_tr_b16 a[118:119], v18 offset:33280
    s_waitcnt lgkmcnt(4)
    v_mfma_f32_16x16x32_bf16 v[80:83], a[124:127], v[104:107], v[80:83]
    v_xor_b32 v17, 0x10000, v17
    ds_read_b64_tr_b16 a[120:121], v17 offset:0
    s_cbranch_vccnz R_G1F8
C_G1F8:
    v_mfma_f32_16x16x32_bf16 v[84:87], a[124:127], v[108:111], v[84:87]
    ds_read_b64_tr_b16 a[122:123], v17 offset:512
    s_waitcnt lgkmcnt(4)
    v_mfma_f32_16x16x32_bf16 v[24:27], a[112:115], v[112:115], v[24:27]
    v_xor_b32 v19, 0x10000, v19
    ds_read_b64_tr_b16 a[124:125], v19 offset:32768
    buffer_load_dwordx4 v[104:107], v12, s[28:31], s69 offen offset:2048 sc1
    v_mfma_f32_16x16x32_bf16 v[28:31], a[112:115], v[116:119], v[28:31]
    ds_read_b64_tr_b16 a[126:127], v19 offset:33280
    s_waitcnt lgkmcnt(4)
    v_mfma_f32_16x16x32_bf16 v[32:35], a[116:119], v[112:115], v[32:35]
    ds_read_b64_tr_b16 a[112:113], v18 offset:0
    buffer_load_dwordx4 v[108:111], v12, s[28:31], s71 offen offset:2048 sc1
    v_mfma_f32_16x16x32_bf16 v[36:39], a[116:119], v[116:119], v[36:39]
    ds_read_b64_tr_b16 a[114:115], v18 offset:512
    s_waitcnt lgkmcnt(4)
    v_mfma_f32_16x16x32_bf16 v[40:43], a[120:123], v[112:115], v[40:43]
    ds_read_b64_tr_b16 a[116:117], v16 offset:32768
    v_mfma_f32_16x16x32_bf16 v[44:47], a[120:123], v[116:119], v[44:47]
    ds_read_b64_tr_b16 a[118:119], v16 offset:33280
    s_waitcnt lgkmcnt(4)
    v_mfma_f32_16x16x32_bf16 v[48:51], a[124:127], v[112:115], v[48:51]
    ds_read_b64_tr_b16 a[120:121], v19 offset:0
    v_mfma_f32_16x16x32_bf16 v[52:55], a[124:127], v[116:119], v[52:55]
    ds_read_b64_tr_b16 a[122:123], v19 offset:512
    s_waitcnt lgkmcnt(4)
    v_mfma_f32_16x16x32_bf16 v[56:59], a[112:115], v[112:115], v[56:59]
    ds_read_b64_tr_b16 a[124:125], v17 offset:32768
    v_mfma_f32_16x16x32_bf16 v[60:63], a[112:115], v[116:119], v[60:63]
    ds_read_b64_tr_b16 a[126:127], v17 offset:33280
    s_waitcnt vmcnt(6) lgkmcnt(4)
    v_mfma_f32_16x16x32_bf16 v[64:67], a[116:119], v[112:115], v[64:67]
    ds_read_b64_tr_b16 a[112:113], v16 offset:4096
    v_max_u32 v14, v127, v123
    v_mfma_f32_16x16x32_bf16 v[68:71], a[116:119], v[116:119], v[68:71]
    ds_read_b64_tr_b16 a[114:115], v16 offset:4608
    s_waitcnt lgkmcnt(4)
    v_mfma_f32_16x16x32_bf16 v[72:75], a[120:123], v[112:115], v[72:75]
    ds_read_b64_tr_b16 a[116:117], v18 offset:36864
    v_cmp_eq_u32 vcc, -1, v14
    v_mfma_f32_16x16x32_bf16 v[76:79], a[120:123], v[116:119], v[76:79]
    ds_read_b64_tr_b16 a[118:119], v18 offset:37376
    s_waitcnt lgkmcnt(4)
    v_mfma_f32_16x16x32_bf16 v[80:83], a[124:127], v[112:115], v[80:83]
    ds_read_b64_tr_b16 a[120:121], v17 offset:4096
    s_cbranch_vccnz R_G1F9
C_G1F9:
    v_mfma_f32_16x16x32_bf16 v[84:87], a[124:127], v[116:119], v[84:87]
    ds_read_b64_tr_b16 a[122:123], v17 offset:4608
    s_waitcnt lgkmcnt(4)
    v_mfma_f32_16x16x32_bf16 v[24:27], a[112:115], v[120:123], v[24:27]
    ds_read_b64_tr_b16 a[124:125], v19 offset:36864
    buffer_load_dwordx4 v[112:115], v12, s[28:31], s69 offen offset:2560 sc1
    v_mfma_f32_16x16x32_bf16 v[28:31], a[112:115], v[124:127], v[28:31]
    ds_read_b64_tr_b16 a[126:127], v19 offset:37376
    s_waitcnt lgkmcnt(4)
    v_mfma_f32_16x16x32_bf16 v[32:35], a[116:119], v[120:123], v[32:35]
    ds_read_b64_tr_b16 a[112:113], v18 offset:4096
    buffer_load_dwordx4 v[116:119], v12, s[28:31], s71 offen offset:2560 sc1
    v_mfma_f32_16x16x32_bf16 v[36:39], a[116:119], v[124:127], v[36:39]
    ds_read_b64_tr_b16 a[114:115], v18 offset:4608
    s_waitcnt lgkmcnt(4)
    v_mfma_f32_16x16x32_bf16 v[40:43], a[120:123], v[120:123], v[40:43]
    ds_read_b64_tr_b16 a[116:117], v16 offset:36864
    v_mfma_f32_16x16x32_bf16 v[44:47], a[120:123], v[124:127], v[44:47]
    ds_read_b64_tr_b16 a[118:119], v16 offset:37376
    s_waitcnt lgkmcnt(4)
    v_mfma_f32_16x16x32_bf16 v[48:51], a[124:127], v[120:123], v[48:51]
    ds_read_b64_tr_b16 a[120:121], v19 offset:4096
    v_mfma_f32_16x16x32_bf16 v[52:55], a[124:127], v[124:127], v[52:55]
    ds_read_b64_tr_b16 a[122:123], v19 offset:4608
    s_waitcnt lgkmcnt(4)
    v_mfma_f32_16x16x32_bf16 v[56:59], a[112:115], v[120:123], v[56:59]
    ds_read_b64_tr_b16 a[124:125], v17 offset:36864
    v_mfma_f32_16x16x32_bf16 v[60:63], a[112:115], v[124:127], v[60:63]
    ds_read_b64_tr_b16 a[126:127], v17 offset:37376
    s_waitcnt vmcnt(6) lgkmcnt(4)
    v_mfma_f32_16x16x32_bf16 v[64:67], a[116:119], v[120:123], v[64:67]
    ds_read_b64_tr_b16 a[112:113], v16 offset:8192
    v_max_u32 v14, v95, v91
    v_mfma_f32_16x16x32_bf16 v[68:71], a[116:119], v[124:127], v[68:71]
    ds_read_b64_tr_b16 a[114:115], v16 offset:8704
    s_waitcnt lgkmcnt(4)
    v_mfma_f32_16x16x32_bf16 v[72:75], a[120:123], v[120:123], v[72:75]
    ds_read_b64_tr_b16 a[116:117], v18 offset:40960
    v_cmp_eq_u32 vcc, -1, v14
    v_mfma_f32_16x16x32_bf16 v[76:79], a[120:123], v[124:127], v[76:79]
    ds_read_b64_tr_b16 a[118:119], v18 offset:41472
    s_waitcnt lgkmcnt(4)
    v_mfma_f32_16x16x32_bf16 v[80:83], a[124:127], v[120:123], v[80:83]
    ds_read_b64_tr_b16 a[120:121], v17 offset:8192
    s_cbranch_vccnz R_G1F10
C_G1F10:
    v_mfma_f32_16x16x32_bf16 v[84:87], a[124:127], v[124:127], v[84:87]
    ds_read_b64_tr_b16 a[122:123], v17 offset:8704
    s_waitcnt lgkmcnt(4)
    v_mfma_f32_16x16x32_bf16 v[24:27], a[112:115], v[88:91], v[24:27]
    ds_read_b64_tr_b16 a[124:125], v19 offset:40960
    buffer_load_dwordx4 v[120:123], v12, s[28:31], s69 offen offset:3072 sc1
    v_mfma_f32_16x16x32_bf16 v[28:31], a[112:115], v[92:95], v[28:31]
    ds_read_b64_tr_b16 a[126:127], v19 offset:41472
    s_waitcnt lgkmcnt(4)
    v_mfma_f32_16x16x32_bf16 v[32:35], a[116:119], v[88:91], v[32:35]
    ds_read_b64_tr_b16 a[112:113], v18 offset:8192
    buffer_load_dwordx4 v[124:127], v12, s[28:31], s71 offen offset:3072 sc1
    v_mfma_f32_16x16x32_bf16 v[36:39], a[116:119], v[92:95], v[36:39]
    ds_read_b64_tr_b16 a[114:115], v18 offset:8704
    s_waitcnt lgkmcnt(4)
    v_mfma_f32_16x16x32_bf16 v[40:43], a[120:123], v[88:91], v[40:43]
    ds_read_b64_tr_b16 a[116:117], v16 offset:40960
    v_mfma_f32_16x16x32_bf16 v[44:47], a[120:123], v[92:95], v[44:47]
    ds_read_b64_tr_b16 a[118:119], v16 offset:41472
    s_waitcnt lgkmcnt(4)
    v_mfma_f32_16x16x32_bf16 v[48:51], a[124:127], v[88:91], v[48:51]
    ds_read_b64_tr_b16 a[120:121], v19 offset:8192
    v_mfma_f32_16x16x32_bf16 v[52:55], a[124:127], v[92:95], v[52:55]
    ds_read_b64_tr_b16 a[122:123], v19 offset:8704
    s_waitcnt lgkmcnt(4)
    v_mfma_f32_16x16x32_bf16 v[56:59], a[112:115], v[88:91], v[56:59]
    ds_read_b64_tr_b16 a[124:125], v17 offset:40960
    v_mfma_f32_16x16x32_bf16 v[60:63], a[112:115], v[92:95], v[60:63]
    ds_read_b64_tr_b16 a[126:127], v17 offset:41472
    s_waitcnt vmcnt(6) lgkmcnt(4)
    v_mfma_f32_16x16x32_bf16 v[64:67], a[116:119], v[88:91], v[64:67]
    ds_read_b64_tr_b16 a[112:113], v16 offset:12288
    v_max_u32 v14, v103, v99
    v_mfma_f32_16x16x32_bf16 v[68:71], a[116:119], v[92:95], v[68:71]
    ds_read_b64_tr_b16 a[114:115], v16 offset:12800
    s_waitcnt lgkmcnt(4)
    v_mfma_f32_16x16x32_bf16 v[72:75], a[120:123], v[88:91], v[72:75]
    ds_read_b64_tr_b16 a[116:117], v18 offset:45056
    v_cmp_eq_u32 vcc, -1, v14
    v_mfma_f32_16x16x32_bf16 v[76:79], a[120:123], v[92:95], v[76:79]
    ds_read_b64_tr_b16 a[118:119], v18 offset:45568
    s_waitcnt lgkmcnt(4)
    v_mfma_f32_16x16x32_bf16 v[80:83], a[124:127], v[88:91], v[80:83]
    ds_read_b64_tr_b16 a[120:121], v17 offset:12288
    s_cbranch_vccnz R_G1F11
C_G1F11:
    v_mfma_f32_16x16x32_bf16 v[84:87], a[124:127], v[92:95], v[84:87]
    ds_read_b64_tr_b16 a[122:123], v17 offset:12800
    s_waitcnt lgkmcnt(4)
    v_mfma_f32_16x16x32_bf16 v[24:27], a[112:115], v[96:99], v[24:27]
    ds_read_b64_tr_b16 a[124:125], v19 offset:45056
    buffer_load_dwordx4 v[88:91], v12, s[28:31], s69 offen offset:3584 sc1
    v_mfma_f32_16x16x32_bf16 v[28:31], a[112:115], v[100:103], v[28:31]
    ds_read_b64_tr_b16 a[126:127], v19 offset:45568
    s_waitcnt lgkmcnt(4)
    v_mfma_f32_16x16x32_bf16 v[32:35], a[116:119], v[96:99], v[32:35]
    ds_read_b64_tr_b16 a[112:113], v18 offset:12288
    buffer_load_dwordx4 v[92:95], v12, s[28:31], s71 offen offset:3584 sc1
    v_mfma_f32_16x16x32_bf16 v[36:39], a[116:119], v[100:103], v[36:39]
    ds_read_b64_tr_b16 a[114:115], v18 offset:12800
    s_waitcnt lgkmcnt(4)
    v_mfma_f32_16x16x32_bf16 v[40:43], a[120:123], v[96:99], v[40:43]
    ds_read_b64_tr_b16 a[116:117], v16 offset:45056
    v_mfma_f32_16x16x32_bf16 v[44:47], a[120:123], v[100:103], v[44:47]
    ds_read_b64_tr_b16 a[118:119], v16 offset:45568
    s_waitcnt lgkmcnt(4)
    v_mfma_f32_16x16x32_bf16 v[48:51], a[124:127], v[96:99], v[48:51]
    ds_read_b64_tr_b16 a[120:121], v19 offset:12288
    v_mfma_f32_16x16x32_bf16 v[52:55], a[124:127], v[100:103], v[52:55]
    ds_read_b64_tr_b16 a[122:123], v19 offset:12800
    s_waitcnt lgkmcnt(4)
    v_mfma_f32_16x16x32_bf16 v[56:59], a[112:115], v[96:99], v[56:59]
    ds_read_b64_tr_b16 a[124:125], v17 offset:45056
    v_mfma_f32_16x16x32_bf16 v[60:63], a[112:115], v[100:103], v[60:63]
    ds_read_b64_tr_b16 a[126:127], v17 offset:45568
    s_waitcnt vmcnt(6) lgkmcnt(4)
    v_mfma_f32_16x16x32_bf16 v[64:67], a[116:119], v[96:99], v[64:67]
    ds_read_b64_tr_b16 a[112:113], v16 offset:16384
    v_max_u32 v14, v111, v107
    v_mfma_f32_16x16x32_bf16 v[68:71], a[116:119], v[100:103], v[68:71]
    ds_read_b64_tr_b16 a[114:115], v16 offset:16896
    s_waitcnt lgkmcnt(4)
    v_mfma_f32_16x16x32_bf16 v[72:75], a[120:123], v[96:99], v[72:75]
    ds_read_b64_tr_b16 a[116:117], v18 offset:49152
    v_cmp_eq_u32 vcc, -1, v14
    v_mfma_f32_16x16x32_bf16 v[76:79], a[120:123], v[100:103], v[76:79]
    ds_read_b64_tr_b16 a[118:119], v18 offset:49664
    s_waitcnt lgkmcnt(4)
    v_mfma_f32_16x16x32_bf16 v[80:83], a[124:127], v[96:99], v[80:83]
    ds_read_b64_tr_b16 a[120:121], v17 offset:16384
    s_cbranch_vccnz R_G1F12
C_G1F12:
    v_mfma_f32_16x16x32_bf16 v[84:87], a[124:127], v[100:103], v[84:87]
    ds_read_b64_tr_b16 a[122:123], v17 offset:16896
    s_waitcnt lgkmcnt(4)
    v_mfma_f32_16x16x32_bf16 v[24:27], a[112:115], v[104:107], v[24:27]
    ds_read_b64_tr_b16 a[124:125], v19 offset:49152
    buffer_store_dwordx4 a[0:3], v2, s[28:31], s67 offen offset:0 sc1
    v_mfma_f32_16x16x32_bf16 v[28:31], a[112:115], v[108:111], v[28:31]
    ds_read_b64_tr_b16 a[126:127], v19 offset:49664
    s_waitcnt lgkmcnt(4)
    v_mfma_f32_16x16x32_bf16 v[32:35], a[116:119], v[104:107], v[32:35]
    ds_read_b64_tr_b16 a[112:113], v18 offset:16384
    buffer_store_dwordx4 a[4:7], v2, s[28:31], s67 offen offset:1024 sc1
    v_mfma_f32_16x16x32_bf16 v[36:39], a[116:119], v[108:111], v[36:39]
    ds_read_b64_tr_b16 a[114:115], v18 offset:16896
    s_waitcnt lgkmcnt(4)
    v_mfma_f32_16x16x32_bf16 v[40:43], a[120:123], v[104:107], v[40:43]
    ds_read_b64_tr_b16 a[116:117], v16 offset:49152
    v_mfma_f32_16x16x32_bf16 v[44:47], a[120:123], v[108:111], v[44:47]
    ds_read_b64_tr_b16 a[118:119], v16 offset:49664
    s_waitcnt lgkmcnt(4)
    v_mfma_f32_16x16x32_bf16 v[48:51], a[124:127], v[104:107], v[48:51]
    ds_read_b64_tr_b16 a[120:121], v19 offset:16384
    v_mfma_f32_16x16x32_bf16 v[52:55], a[124:127], v[108:111], v[52:55]
    ds_read_b64_tr_b16 a[122:123], v19 offset:16896
    s_waitcnt lgkmcnt(4)
    v_mfma_f32_16x16x32_bf16 v[56:59], a[112:115], v[104:107], v[56:59]
    ds_read_b64_tr_b16 a[124:125], v17 offset:49152
    v_mfma_f32_16x16x32_bf16 v[60:63], a[112:115], v[108:111], v[60:63]
    ds_read_b64_tr_b16 a[126:127], v17 offset:49664
    s_waitcnt vmcnt(6) lgkmcnt(4)
    v_mfma_f32_16x16x32_bf16 v[64:67], a[116:119], v[104:107], v[64:67]
    ds_read_b64_tr_b16 a[112:113], v16 offset:20480
    v_max_u32 v14, v119, v115
    v_mfma_f32_16x16x32_bf16 v[68:71], a[116:119], v[108:111], v[68:71]
    ds_read_b64_tr_b16 a[114:115], v16 offset:20992
    s_waitcnt lgkmcnt(4)
    v_mfma_f32_16x16x32_bf16 v[72:75], a[120:123], v[104:107], v[72:75]
    ds_read_b64_tr_b16 a[116:117], v18 offset:53248
    v_cmp_eq_u32 vcc, -1, v14
    v_mfma_f32_16x16x32_bf16 v[76:79], a[120:123], v[108:111], v[76:79]
    ds_read_b64_tr_b16 a[118:119], v18 offset:53760
    s_waitcnt lgkmcnt(4)
    v_mfma_f32_16x16x32_bf16 v[80:83], a[124:127], v[104:107], v[80:83]
    ds_read_b64_tr_b16 a[120:121], v17 offset:20480
    s_cbranch_vccnz R_G1F13
C_G1F13:
    v_mfma_f32_16x16x32_bf16 v[84:87], a[124:127], v[108:111], v[84:87]
    ds_read_b64_tr_b16 a[122:123], v17 offset:20992
    s_waitcnt lgkmcnt(4)
    v_mfma_f32_16x16x32_bf16 v[24:27], a[112:115], v[112:115], v[24:27]
    ds_read_b64_tr_b16 a[124:125], v19 offset:53248
    v_mfma_f32_16x16x32_bf16 v[28:31], a[112:115], v[116:119], v[28:31]
    ds_read_b64_tr_b16 a[126:127], v19 offset:53760
    s_waitcnt lgkmcnt(4)
    v_mfma_f32_16x16x32_bf16 v[32:35], a[116:119], v[112:115], v[32:35]
    ds_read_b64_tr_b16 a[112:113], v18 offset:20480
    v_mfma_f32_16x16x32_bf16 v[36:39], a[116:119], v[116:119], v[36:39]
    ds_read_b64_tr_b16 a[114:115], v18 offset:20992
    s_waitcnt lgkmcnt(4)
    v_mfma_f32_16x16x32_bf16 v[40:43], a[120:123], v[112:115], v[40:43]
    ds_read_b64_tr_b16 a[116:117], v16 offset:53248
    v_mfma_f32_16x16x32_bf16 v[44:47], a[120:123], v[116:119], v[44:47]
    ds_read_b64_tr_b16 a[118:119], v16 offset:53760
    s_waitcnt lgkmcnt(4)
    v_mfma_f32_16x16x32_bf16 v[48:51], a[124:127], v[112:115], v[48:51]
    ds_read_b64_tr_b16 a[120:121], v19 offset:20480
    v_mfma_f32_16x16x32_bf16 v[52:55], a[124:127], v[116:119], v[52:55]
    ds_read_b64_tr_b16 a[122:123], v19 offset:20992
    s_waitcnt lgkmcnt(4)
    v_mfma_f32_16x16x32_bf16 v[56:59], a[112:115], v[112:115], v[56:59]
    ds_read_b64_tr_b16 a[124:125], v17 offset:53248
    v_mfma_f32_16x16x32_bf16 v[60:63], a[112:115], v[116:119], v[60:63]
    ds_read_b64_tr_b16 a[126:127], v17 offset:53760
    s_waitcnt vmcnt(4) lgkmcnt(4)
    v_mfma_f32_16x16x32_bf16 v[64:67], a[116:119], v[112:115], v[64:67]
    ds_read_b64_tr_b16 a[112:113], v16 offset:24576
    v_max_u32 v14, v127, v123
    v_mfma_f32_16x16x32_bf16 v[68:71], a[116:119], v[116:119], v[68:71]
    ds_read_b64_tr_b16 a[114:115], v16 offset:25088
    s_waitcnt lgkmcnt(4)
    v_mfma_f32_16x16x32_bf16 v[72:75], a[120:123], v[112:115], v[72:75]
    ds_read_b64_tr_b16 a[116:117], v18 offset:57344
    v_cmp_eq_u32 vcc, -1, v14
    v_mfma_f32_16x16x32_bf16 v[76:79], a[120:123], v[116:119], v[76:79]
    ds_read_b64_tr_b16 a[118:119], v18 offset:57856
    s_waitcnt lgkmcnt(4)
    v_mfma_f32_16x16x32_bf16 v[80:83], a[124:127], v[112:115], v[80:83]
    ds_read_b64_tr_b16 a[120:121], v17 offset:24576
    s_cbranch_vccnz R_G1F14
C_G1F14:
    v_mfma_f32_16x16x32_bf16 v[84:87], a[124:127], v[116:119], v[84:87]
    ds_read_b64_tr_b16 a[122:123], v17 offset:25088
    s_waitcnt lgkmcnt(4)
    v_mfma_f32_16x16x32_bf16 v[24:27], a[112:115], v[120:123], v[24:27]
    ds_read_b64_tr_b16 a[124:125], v19 offset:57344
    v_mfma_f32_16x16x32_bf16 v[28:31], a[112:115], v[124:127], v[28:31]
    ds_read_b64_tr_b16 a[126:127], v19 offset:57856
    s_waitcnt lgkmcnt(4)
    v_mfma_f32_16x16x32_bf16 v[32:35], a[116:119], v[120:123], v[32:35]
    ds_read_b64_tr_b16 a[112:113], v18 offset:24576
    v_mfma_f32_16x16x32_bf16 v[36:39], a[116:119], v[124:127], v[36:39]
    ds_read_b64_tr_b16 a[114:115], v18 offset:25088
    s_waitcnt lgkmcnt(4)
    v_mfma_f32_16x16x32_bf16 v[40:43], a[120:123], v[120:123], v[40:43]
    ds_read_b64_tr_b16 a[116:117], v16 offset:57344
    v_mfma_f32_16x16x32_bf16 v[44:47], a[120:123], v[124:127], v[44:47]
    ds_read_b64_tr_b16 a[118:119], v16 offset:57856
    s_waitcnt lgkmcnt(4)
    v_mfma_f32_16x16x32_bf16 v[48:51], a[124:127], v[120:123], v[48:51]
    ds_read_b64_tr_b16 a[120:121], v19 offset:24576
    v_mfma_f32_16x16x32_bf16 v[52:55], a[124:127], v[124:127], v[52:55]
    ds_read_b64_tr_b16 a[122:123], v19 offset:25088
    s_waitcnt lgkmcnt(4)
    v_mfma_f32_16x16x32_bf16 v[56:59], a[112:115], v[120:123], v[56:59]
    ds_read_b64_tr_b16 a[124:125], v17 offset:57344
    v_mfma_f32_16x16x32_bf16 v[60:63], a[112:115], v[124:127], v[60:63]
    ds_read_b64_tr_b16 a[126:127], v17 offset:57856
    s_waitcnt vmcnt(2) lgkmcnt(4)
    v_mfma_f32_16x16x32_bf16 v[64:67], a[116:119], v[120:123], v[64:67]
    ds_read_b64_tr_b16 a[112:113], v16 offset:28672
    v_max_u32 v14, v95, v91
    v_mfma_f32_16x16x32_bf16 v[68:71], a[116:119], v[124:127], v[68:71]
    ds_read_b64_tr_b16 a[114:115], v16 offset:29184
    s_waitcnt lgkmcnt(4)
    v_mfma_f32_16x16x32_bf16 v[72:75], a[120:123], v[120:123], v[72:75]
    ds_read_b64_tr_b16 a[116:117], v18 offset:61440
    v_cmp_eq_u32 vcc, -1, v14
    v_mfma_f32_16x16x32_bf16 v[76:79], a[120:123], v[124:127], v[76:79]
    ds_read_b64_tr_b16 a[118:119], v18 offset:61952
    s_waitcnt lgkmcnt(4)
    v_mfma_f32_16x16x32_bf16 v[80:83], a[124:127], v[120:123], v[80:83]
    ds_read_b64_tr_b16 a[120:121], v17 offset:28672
    s_cbranch_vccnz R_G1F15
C_G1F15:
    v_mfma_f32_16x16x32_bf16 v[84:87], a[124:127], v[124:127], v[84:87]
    ds_read_b64_tr_b16 a[122:123], v17 offset:29184
    s_waitcnt lgkmcnt(4)
    v_mfma_f32_16x16x32_bf16 v[24:27], a[112:115], v[88:91], v[24:27]
    ds_read_b64_tr_b16 a[124:125], v19 offset:61440
    v_mfma_f32_16x16x32_bf16 v[28:31], a[112:115], v[92:95], v[28:31]
    ds_read_b64_tr_b16 a[126:127], v19 offset:61952
    s_waitcnt lgkmcnt(4)
    v_mfma_f32_16x16x32_bf16 v[32:35], a[116:119], v[88:91], v[32:35]
    ds_read_b64_tr_b16 a[112:113], v18 offset:28672
    v_mfma_f32_16x16x32_bf16 v[36:39], a[116:119], v[92:95], v[36:39]
    ds_read_b64_tr_b16 a[114:115], v18 offset:29184
    s_waitcnt lgkmcnt(4)
    v_mfma_f32_16x16x32_bf16 v[40:43], a[120:123], v[88:91], v[40:43]
    ds_read_b64_tr_b16 a[116:117], v16 offset:61440
    v_mfma_f32_16x16x32_bf16 v[44:47], a[120:123], v[92:95], v[44:47]
    ds_read_b64_tr_b16 a[118:119], v16 offset:61952
    s_waitcnt lgkmcnt(4)
    v_mfma_f32_16x16x32_bf16 v[48:51], a[124:127], v[88:91], v[48:51]
    ds_read_b64_tr_b16 a[120:121], v19 offset:28672
    v_mfma_f32_16x16x32_bf16 v[52:55], a[124:127], v[92:95], v[52:55]
    ds_read_b64_tr_b16 a[122:123], v19 offset:29184
    s_waitcnt lgkmcnt(4)
    v_mfma_f32_16x16x32_bf16 v[56:59], a[112:115], v[88:91], v[56:59]
    ds_read_b64_tr_b16 a[124:125], v17 offset:61440
    v_mfma_f32_16x16x32_bf16 v[60:63], a[112:115], v[92:95], v[60:63]
    ds_read_b64_tr_b16 a[126:127], v17 offset:61952
    s_waitcnt lgkmcnt(4)
    v_mfma_f32_16x16x32_bf16 v[64:67], a[116:119], v[88:91], v[64:67]
    v_mfma_f32_16x16x32_bf16 v[68:71], a[116:119], v[92:95], v[68:71]
    s_waitcnt lgkmcnt(2)
    v_mfma_f32_16x16x32_bf16 v[72:75], a[120:123], v[88:91], v[72:75]
    v_mfma_f32_16x16x32_bf16 v[76:79], a[120:123], v[92:95], v[76:79]
    s_waitcnt lgkmcnt(0)
    v_mfma_f32_16x16x32_bf16 v[80:83], a[124:127], v[88:91], v[80:83]
    v_mfma_f32_16x16x32_bf16 v[84:87], a[124:127], v[92:95], v[84:87]
    v_mov_b32 v6, 117
    ds_write_b32 v0, v6
    s_setprio 3
    v_fma_f32 v120, v24, v24, s76
    v_fma_f32 v121, v25, v25, s76
    v_fma_f32 v122, v26, v26, s76
    v_fma_f32 v123, v27, v27, s76
    v_mul_f32 v32, v24, v32
    v_mul_f32 v33, v25, v33
    v_mul_f32 v34, v26, v34
    v_mul_f32 v35, v27, v35
    v_mul_f32 v24, -v24, v120
    v_mul_f32 v25, -v25, v121
    v_mul_f32 v26, -v26, v122
    v_mul_f32 v27, -v27, v123
    v_fma_f32 v120, v28, v28, s76
    v_fma_f32 v121, v29, v29, s76
    v_fma_f32 v122, v30, v30, s76
    v_fma_f32 v123, v31, v31, s76
    v_mul_f32 v36, v28, v36
    v_mul_f32 v37, v29, v37
    v_mul_f32 v38, v30, v38
    v_mul_f32 v39, v31, v39
    v_mul_f32 v28, -v28, v120
    v_mul_f32 v29, -v29, v121
    v_mul_f32 v30, -v30, v122
    v_mul_f32 v31, -v31, v123
    v_exp_f32 v24, v24
    v_exp_f32 v25, v25
    v_exp_f32 v26, v26
    v_exp_f32 v27, v27
    v_exp_f32 v28, v28
    v_exp_f32 v29, v29
    v_exp_f32 v30, v30
    v_exp_f32 v31, v31
    v_fma_f32 v24, v24, s77, s77
    v_fma_f32 v25, v25, s77, s77
    v_fma_f32 v26, v26, s77, s77
    v_fma_f32 v27, v27, s77, s77
    v_fma_f32 v28, v28, s77, s77
    v_fma_f32 v29, v29, s77, s77
    v_fma_f32 v30, v30, s77, s77
    v_fma_f32 v31, v31, s77, s77
    v_rcp_f32 v24, v24
    v_rcp_f32 v25, v25
    v_rcp_f32 v26, v26
    v_rcp_f32 v27, v27
    v_rcp_f32 v28, v28
    v_rcp_f32 v29, v29
    v_rcp_f32 v30, v30
    v_rcp_f32 v31, v31
    v_mul_f32 v32, v32, v24
    v_mul_f32 v33, v33, v25
    v_mul_f32 v34, v34, v26
    v_mul_f32 v35, v35, v27
    v_mul_f32 v36, v36, v28
    v_mul_f32 v37, v37, v29
    v_mul_f32 v38, v38, v30
    v_mul_f32 v39, v39, v31
    v_cvt_pk_bf16_f32 v24, v32, v33
    v_cvt_pk_bf16_f32 v26, v36, v37
    v_cvt_pk_bf16_f32 v25, v34, v35
    v_cvt_pk_bf16_f32 v27, v38, v39
    v_bfi_b32 v24, v3, s57, v24
    v_bfi_b32 v26, v3, s57, v26
    v_bfi_b32 v25, v3, s57, v25
    v_bfi_b32 v27, v3, s57, v27
    v_permlane16_swap_b32 v24, v26
    s_nop 0
    v_permlane16_swap_b32 v25, v27
    buffer_store_dwordx4 v[24:27], v2, s[28:31], s72 offen sc1
    v_fma_f32 v120, v40, v40, s76
    v_fma_f32 v121, v41, v41, s76
    v_fma_f32 v122, v42, v42, s76
    v_fma_f32 v123, v43, v43, s76
    v_mul_f32 v48, v40, v48
    v_mul_f32 v49, v41, v49
    v_mul_f32 v50, v42, v50
    v_mul_f32 v51, v43, v51
    v_mul_f32 v40, -v40, v120
    v_mul_f32 v41, -v41, v121
    v_mul_f32 v42, -v42, v122
    v_mul_f32 v43, -v43, v123
    v_fma_f32 v120, v44, v44, s76
    v_fma_f32 v121, v45, v45, s76
    v_fma_f32 v122, v46, v46, s76
    v_fma_f32 v123, v47, v47, s76
    v_mul_f32 v52, v44, v52
    v_mul_f32 v53, v45, v53
    v_mul_f32 v54, v46, v54
    v_mul_f32 v55, v47, v55
    v_mul_f32 v44, -v44, v120
    v_mul_f32 v45, -v45, v121
    v_mul_f32 v46, -v46, v122
    v_mul_f32 v47, -v47, v123
    v_exp_f32 v40, v40
    v_exp_f32 v41, v41
    v_exp_f32 v42, v42
    v_exp_f32 v43, v43
    v_exp_f32 v44, v44
    v_exp_f32 v45, v45
    v_exp_f32 v46, v46
    v_exp_f32 v47, v47
    v_fma_f32 v40, v40, s77, s77
    v_fma_f32 v41, v41, s77, s77
    v_fma_f32 v42, v42, s77, s77
    v_fma_f32 v43, v43, s77, s77
    v_fma_f32 v44, v44, s77, s77
    v_fma_f32 v45, v45, s77, s77
    v_fma_f32 v46, v46, s77, s77
    v_fma_f32 v47, v47, s77, s77
    v_rcp_f32 v40, v40
    v_rcp_f32 v41, v41
    v_rcp_f32 v42, v42
    v_rcp_f32 v43, v43
    v_rcp_f32 v44, v44
    v_rcp_f32 v45, v45
    v_rcp_f32 v46, v46
    v_rcp_f32 v47, v47
    v_mul_f32 v48, v48, v40
    v_mul_f32 v49, v49, v41
    v_mul_f32 v50, v50, v42
    v_mul_f32 v51, v51, v43
    v_mul_f32 v52, v52, v44
    v_mul_f32 v53, v53, v45
    v_mul_f32 v54, v54, v46
    v_mul_f32 v55, v55, v47
    v_cvt_pk_bf16_f32 v40, v48, v49
    v_cvt_pk_bf16_f32 v42, v52, v53
    v_cvt_pk_bf16_f32 v41, v50, v51
    v_cvt_pk_bf16_f32 v43, v54, v55
    v_bfi_b32 v40, v3, s57, v40
    v_bfi_b32 v42, v3, s57, v42
    v_bfi_b32 v41, v3, s57, v41
    v_bfi_b32 v43, v3, s57, v43
    v_permlane16_swap_b32 v40, v42
    s_nop 0
    v_permlane16_swap_b32 v41, v43
    buffer_store_dwordx4 v[40:43], v2, s[28:31], s73 offen sc1
    v_fma_f32 v120, v56, v56, s76
    v_fma_f32 v121, v57, v57, s76
    v_fma_f32 v122, v58, v58, s76
    v_fma_f32 v123, v59, v59, s76
    v_mul_f32 v64, v56, v64
    v_mul_f32 v65, v57, v65
    v_mul_f32 v66, v58, v66
    v_mul_f32 v67, v59, v67
    v_mul_f32 v56, -v56, v120
    v_mul_f32 v57, -v57, v121
    v_mul_f32 v58, -v58, v122
    v_mul_f32 v59, -v59, v123
    v_fma_f32 v120, v60, v60, s76
    v_fma_f32 v121, v61, v61, s76
    v_fma_f32 v122, v62, v62, s76
    v_fma_f32 v123, v63, v63, s76
    v_mul_f32 v68, v60, v68
    v_mul_f32 v69, v61, v69
    v_mul_f32 v70, v62, v70
    v_mul_f32 v71, v63, v71
    v_mul_f32 v60, -v60, v120
    v_mul_f32 v61, -v61, v121
    v_mul_f32 v62, -v62, v122
    v_mul_f32 v63, -v63, v123
    v_exp_f32 v56, v56
    v_exp_f32 v57, v57
    v_exp_f32 v58, v58
    v_exp_f32 v59, v59
    v_exp_f32 v60, v60
    v_exp_f32 v61, v61
    v_exp_f32 v62, v62
    v_exp_f32 v63, v63
    v_fma_f32 v56, v56, s77, s77
    v_fma_f32 v57, v57, s77, s77
    v_fma_f32 v58, v58, s77, s77
    v_fma_f32 v59, v59, s77, s77
    v_fma_f32 v60, v60, s77, s77
    v_fma_f32 v61, v61, s77, s77
    v_fma_f32 v62, v62, s77, s77
    v_fma_f32 v63, v63, s77, s77
    v_rcp_f32 v56, v56
    v_rcp_f32 v57, v57
    v_rcp_f32 v58, v58
    v_rcp_f32 v59, v59
    v_rcp_f32 v60, v60
    v_rcp_f32 v61, v61
    v_rcp_f32 v62, v62
    v_rcp_f32 v63, v63
    v_mul_f32 v64, v64, v56
    v_mul_f32 v65, v65, v57
    v_mul_f32 v66, v66, v58
    v_mul_f32 v67, v67, v59
    v_mul_f32 v68, v68, v60
    v_mul_f32 v69, v69, v61
    v_mul_f32 v70, v70, v62
    v_mul_f32 v71, v71, v63
    v_cvt_pk_bf16_f32 v56, v64, v65
    v_cvt_pk_bf16_f32 v58, v68, v69
    v_cvt_pk_bf16_f32 v57, v66, v67
    v_cvt_pk_bf16_f32 v59, v70, v71
    v_bfi_b32 v56, v3, s57, v56
    v_bfi_b32 v58, v3, s57, v58
    v_bfi_b32 v57, v3, s57, v57
    v_bfi_b32 v59, v3, s57, v59
    v_permlane16_swap_b32 v56, v58
    s_nop 0
    v_permlane16_swap_b32 v57, v59
    buffer_store_dwordx4 v[56:59], v2, s[28:31], s74 offen sc1
    v_fma_f32 v120, v72, v72, s76
    v_fma_f32 v121, v73, v73, s76
    v_fma_f32 v122, v74, v74, s76
    v_fma_f32 v123, v75, v75, s76
    v_mul_f32 v80, v72, v80
    v_mul_f32 v81, v73, v81
    v_mul_f32 v82, v74, v82
    v_mul_f32 v83, v75, v83
    v_mul_f32 v72, -v72, v120
    v_mul_f32 v73, -v73, v121
    v_mul_f32 v74, -v74, v122
    v_mul_f32 v75, -v75, v123
    v_fma_f32 v120, v76, v76, s76
    v_fma_f32 v121, v77, v77, s76
    v_fma_f32 v122, v78, v78, s76
    v_fma_f32 v123, v79, v79, s76
    v_mul_f32 v84, v76, v84
    v_mul_f32 v85, v77, v85
    v_mul_f32 v86, v78, v86
    v_mul_f32 v87, v79, v87
    v_mul_f32 v76, -v76, v120
    v_mul_f32 v77, -v77, v121
    v_mul_f32 v78, -v78, v122
    v_mul_f32 v79, -v79, v123
    v_exp_f32 v72, v72
    v_exp_f32 v73, v73
    v_exp_f32 v74, v74
    v_exp_f32 v75, v75
    v_exp_f32 v76, v76
    v_exp_f32 v77, v77
    v_exp_f32 v78, v78
    v_exp_f32 v79, v79
    v_fma_f32 v72, v72, s77, s77
    v_fma_f32 v73, v73, s77, s77
    v_fma_f32 v74, v74, s77, s77
    v_fma_f32 v75, v75, s77, s77
    v_fma_f32 v76, v76, s77, s77
    v_fma_f32 v77, v77, s77, s77
    v_fma_f32 v78, v78, s77, s77
    v_fma_f32 v79, v79, s77, s77
    v_rcp_f32 v72, v72
    v_rcp_f32 v73, v73
    v_rcp_f32 v74, v74
    v_rcp_f32 v75, v75
    v_rcp_f32 v76, v76
    v_rcp_f32 v77, v77
    v_rcp_f32 v78, v78
    v_rcp_f32 v79, v79
    v_mul_f32 v80, v80, v72
    v_mul_f32 v81, v81, v73
    v_mul_f32 v82, v82, v74
    v_mul_f32 v83, v83, v75
    v_mul_f32 v84, v84, v76
    v_mul_f32 v85, v85, v77
    v_mul_f32 v86, v86, v78
    v_mul_f32 v87, v87, v79
    v_cvt_pk_bf16_f32 v72, v80, v81
    v_cvt_pk_bf16_f32 v74, v84, v85
    v_cvt_pk_bf16_f32 v73, v82, v83
    v_cvt_pk_bf16_f32 v75, v86, v87
    v_bfi_b32 v72, v3, s57, v72
    v_bfi_b32 v74, v3, s57, v74
    v_bfi_b32 v73, v3, s57, v73
    v_bfi_b32 v75, v3, s57, v75
    v_permlane16_swap_b32 v72, v74
    s_nop 0
    v_permlane16_swap_b32 v73, v75
    buffer_store_dwordx4 v[72:75], v2, s[28:31], s75 offen sc1
    buffer_load_dwordx4 v[88:91], v22, s[28:31], s78 offen sc1
    buffer_load_dwordx4 v[92:95], v22, s[28:31], s79 offen sc1
    s_setprio 0
Rd0:
    ds_read_b32 v14, v15
    s_add_u32 s51, s51, 1
    s_cmp_lt_u32 s51, 3200000
    s_cbranch_scc0 Rd0c
    s_waitcnt lgkmcnt(0)
    v_cmp_gt_u32 vcc, 120, v14
    s_nop 0
    s_cbranch_vccnz Rd0
Rd0c:
    s_setprio 0
    ds_read_b128 v[24:27], v20 offset:0
    ds_read_b128 v[28:31], v21 offset:0
    ds_read_b128 v[32:35], v20 offset:8192
    ds_read_b128 v[36:39], v21 offset:8192
    ds_read_b128 v[40:43], v20 offset:16384
    ds_read_b128 v[44:47], v21 offset:16384
    ds_read_b128 v[48:51], v20 offset:24576
    ds_read_b128 v[52:55], v21 offset:24576
    s_waitcnt lgkmcnt(5)
    v_add_f32 v24, v24, v32
    v_add_f32 v25, v25, v33
    v_add_f32 v26, v26, v34
    v_add_f32 v27, v27, v35
    s_waitcnt lgkmcnt(4)
    v_add_f32 v28, v28, v36
    v_add_f32 v29, v29, v37
    v_add_f32 v30, v30, v38
    v_add_f32 v31, v31, v39
    s_waitcnt lgkmcnt(3)
    v_add_f32 v24, v24, v40
    v_add_f32 v25, v25, v41
    v_add_f32 v26, v26, v42
    v_add_f32 v27, v27, v43
    s_waitcnt lgkmcnt(2)
    v_add_f32 v28, v28, v44
    v_add_f32 v29, v29, v45
    v_add_f32 v30, v30, v46
    v_add_f32 v31, v31, v47
    s_waitcnt lgkmcnt(1)
    v_add_f32 v24, v24, v48
    v_add_f32 v25, v25, v49
    v_add_f32 v26, v26, v50
    v_add_f32 v27, v27, v51
    s_waitcnt lgkmcnt(0)
    v_add_f32 v28, v28, v52
    v_add_f32 v29, v29, v53
    v_add_f32 v30, v30, v54
    v_add_f32 v31, v31, v55
    v_ldexp_f32 v24, v24, s86
    v_ldexp_f32 v25, v25, s86
    v_ldexp_f32 v26, v26, s86
    v_ldexp_f32 v27, v27, s86
    v_ldexp_f32 v28, v28, s86
    v_ldexp_f32 v29, v29, s86
    v_ldexp_f32 v30, v30, s86
    v_ldexp_f32 v31, v31, s86
    v_cvt_pk_bf16_f32 v24, v24, v25
    v_cvt_pk_bf16_f32 v25, v26, v27
    v_cvt_pk_bf16_f32 v26, v28, v29
    v_cvt_pk_bf16_f32 v27, v30, v31
    v_bfi_b32 v24, v3, s57, v24
    v_bfi_b32 v25, v3, s57, v25
    v_bfi_b32 v26, v3, s57, v26
    v_bfi_b32 v27, v3, s57, v27
    buffer_store_dwordx4 v[24:27], v2, s[28:31], s84 offen offset:0 sc1
    s_setprio 0
Rd1:
    ds_read_b32 v14, v15
    s_add_u32 s51, s51, 1
    s_cmp_lt_u32 s51, 3200000
    s_cbranch_scc0 Rd1c
    s_waitcnt lgkmcnt(0)
    v_cmp_gt_u32 vcc, 121, v14
    s_nop 0
    s_cbranch_vccnz Rd1
Rd1c:
    s_setprio 0
    ds_read_b128 v[56:59], v20 offset:32768
    ds_read_b128 v[60:63], v21 offset:32768
    ds_read_b128 v[64:67], v20 offset:40960
    ds_read_b128 v[68:71], v21 offset:40960
    ds_read_b128 v[72:75], v20 offset:49152
    ds_read_b128 v[76:79], v21 offset:49152
    ds_read_b128 v[80:83], v20 offset:57344
    ds_read_b128 v[84:87], v21 offset:57344
    s_waitcnt lgkmcnt(5)
    v_add_f32 v56, v56, v64
    v_add_f32 v57, v57, v65
    v_add_f32 v58, v58, v66
    v_add_f32 v59, v59, v67
    s_waitcnt lgkmcnt(4)
    v_add_f32 v60, v60, v68
    v_add_f32 v61, v61, v69
    v_add_f32 v62, v62, v70
    v_add_f32 v63, v63, v71
    s_waitcnt lgkmcnt(3)
    v_add_f32 v56, v56, v72
    v_add_f32 v57, v57, v73
    v_add_f32 v58, v58, v74
    v_add_f32 v59, v59, v75
    s_waitcnt lgkmcnt(2)
    v_add_f32 v60, v60, v76
    v_add_f32 v61, v61, v77
    v_add_f32 v62, v62, v78
    v_add_f32 v63, v63, v79
    s_waitcnt lgkmcnt(1)
    v_add_f32 v56, v56, v80
    v_add_f32 v57, v57, v81
    v_add_f32 v58, v58, v82
    v_add_f32 v59, v59, v83
    s_waitcnt lgkmcnt(0)
    v_add_f32 v60, v60, v84
    v_add_f32 v61, v61, v85
    v_add_f32 v62, v62, v86
    v_add_f32 v63, v63, v87
    v_ldexp_f32 v56, v56, s86
    v_ldexp_f32 v57, v57, s86
    v_ldexp_f32 v58, v58, s86
    v_ldexp_f32 v59, v59, s86
    v_ldexp_f32 v60, v60, s86
    v_ldexp_f32 v61, v61, s86
    v_ldexp_f32 v62, v62, s86
    v_ldexp_f32 v63, v63, s86
    v_cvt_pk_bf16_f32 v56, v56, v57
    v_cvt_pk_bf16_f32 v57, v58, v59
    v_cvt_pk_bf16_f32 v58, v60, v61
    v_cvt_pk_bf16_f32 v59, v62, v63
    v_bfi_b32 v56, v3, s57, v56
    v_bfi_b32 v57, v3, s57, v57
    v_bfi_b32 v58, v3, s57, v58
    v_bfi_b32 v59, v3, s57, v59
    buffer_store_dwordx4 v[56:59], v2, s[28:31], s84 offen offset:1024 sc1
    v_xor_b32 v20, 0x10000, v20
    v_xor_b32 v21, 0x10000, v21
    s_waitcnt vmcnt(3)
    v_xor_b32 v14, s57, v88
    v_bitop3_b32 v14, v14, v91, s57 bitop3:0xf6
    s_waitcnt vmcnt(2)
    v_bitop3_b32 v14, v14, v92, s57 bitop3:0xf6
    v_bitop3_b32 v14, v14, v95, s57 bitop3:0xf6
    v_and_b32 v14, v3, v14
    v_cmp_ne_u32 vcc, 0, v14
    s_nop 0
    s_cbranch_vccnz R_H
C_H:
    v_lshlrev_b32 v104, 16, v88
    v_and_b32 v105, 0xffff0000, v88
    v_lshlrev_b32 v106, 16, v89
    v_and_b32 v107, 0xffff0000, v89
    v_lshlrev_b32 v108, 16, v90
    v_and_b32 v109, 0xffff0000, v90
    v_lshlrev_b32 v110, 16, v91
    v_and_b32 v111, 0xffff0000, v91
    v_lshlrev_b32 v112, 16, v92
    v_and_b32 v113, 0xffff0000, v92
    v_lshlrev_b32 v114, 16, v93
    v_and_b32 v115, 0xffff0000, v93
    v_lshlrev_b32 v116, 16, v94
    v_and_b32 v117, 0xffff0000, v94
    v_lshlrev_b32 v118, 16, v95
    v_and_b32 v119, 0xffff0000, v95
    s_setprio 0
Rd2:
    ds_read_b32 v14, v15
    s_add_u32 s51, s51, 1
    s_cmp_lt_u32 s51, 3200000
    s_cbranch_scc0 Rd2c
    s_waitcnt lgkmcnt(0)
    v_cmp_gt_u32 vcc, 122, v14
    s_nop 0
    s_cbranch_vccnz Rd2
Rd2c:
    s_setprio 0
    ds_read_b128 v[24:27], v20 offset:0
    ds_read_b128 v[28:31], v21 offset:0
    ds_read_b128 v[32:35], v20 offset:8192
    ds_read_b128 v[36:39], v21 offset:8192
    ds_read_b128 v[40:43], v20 offset:16384
    ds_read_b128 v[44:47], v21 offset:16384
    ds_read_b128 v[48:51], v20 offset:24576
    ds_read_b128 v[52:55], v21 offset:24576
    buffer_load_dwordx4 v[96:99], v2, s[28:31], s85 offen offset:0 sc1
    buffer_load_dwordx4 v[100:103], v2, s[28:31], s85 offen offset:1024 sc1
    s_waitcnt lgkmcnt(7)
    v_add_f32 v104, v104, v24
    v_add_f32 v105, v105, v25
    v_add_f32 v106, v106, v26
    v_add_f32 v107, v107, v27
    s_waitcnt lgkmcnt(6)
    v_add_f32 v108, v108, v28
    v_add_f32 v109, v109, v29
    v_add_f32 v110, v110, v30
    v_add_f32 v111, v111, v31
    s_waitcnt lgkmcnt(5)
    v_add_f32 v104, v104, v32
    v_add_f32 v105, v105, v33
    v_add_f32 v106, v106, v34
    v_add_f32 v107, v107, v35
    s_waitcnt lgkmcnt(4)
    v_add_f32 v108, v108, v36
    v_add_f32 v109, v109, v37
    v_add_f32 v110, v110, v38
    v_add_f32 v111, v111, v39
    s_waitcnt lgkmcnt(3)
    v_add_f32 v104, v104, v40
    v_add_f32 v105, v105, v41
    v_add_f32 v106, v106, v42
    v_add_f32 v107, v107, v43
    s_waitcnt lgkmcnt(2)
    v_add_f32 v108, v108, v44
    v_add_f32 v109, v109, v45
    v_add_f32 v110, v110, v46
    v_add_f32 v111, v111, v47
    s_waitcnt lgkmcnt(1)
    v_add_f32 v104, v104, v48
    v_add_f32 v105, v105, v49
    v_add_f32 v106, v106, v50
    v_add_f32 v107, v107, v51
    s_waitcnt lgkmcnt(0)
    v_add_f32 v108, v108, v52
    v_add_f32 v109, v109, v53
    v_add_f32 v110, v110, v54
    v_add_f32 v111, v111, v55
    s_waitcnt vmcnt(0)
    v_xor_b32 v14, s57, v103
    v_bitop3_b32 v14, v14, v100, s57 bitop3:0xf6
    v_bitop3_b32 v14, v14, v99, s57 bitop3:0xf6
    v_bitop3_b32 v14, v14, v96, s57 bitop3:0xf6
    v_and_b32 v14, v3, v14
    v_cmp_ne_u32 vcc, 0, v14
    s_nop 0
    s_cbranch_vccnz R_XP
C_XP:
    v_lshlrev_b32 v24, 16, v96
    v_and_b32 v25, 0xffff0000, v96
    v_lshlrev_b32 v26, 16, v97
    v_and_b32 v27, 0xffff0000, v97
    v_lshlrev_b32 v28, 16, v98
    v_and_b32 v29, 0xffff0000, v98
    v_lshlrev_b32 v30, 16, v99
    v_and_b32 v31, 0xffff0000, v99
    v_lshlrev_b32 v32, 16, v100
    v_and_b32 v33, 0xffff0000, v100
    v_lshlrev_b32 v34, 16, v101
    v_and_b32 v35, 0xffff0000, v101
    v_lshlrev_b32 v36, 16, v102
    v_and_b32 v37, 0xffff0000, v102
    v_lshlrev_b32 v38, 16, v103
    v_and_b32 v39, 0xffff0000, v103
    v_pk_add_f32 v[104:105], v[104:105], v[24:25]
    v_pk_add_f32 v[106:107], v[106:107], v[26:27]
    v_pk_add_f32 v[108:109], v[108:109], v[28:29]
    v_pk_add_f32 v[110:111], v[110:111], v[30:31]
    v_pk_add_f32 v[112:113], v[112:113], v[32:33]
    v_pk_add_f32 v[114:115], v[114:115], v[34:35]
    v_pk_add_f32 v[116:117], v[116:117], v[36:37]
    v_pk_add_f32 v[118:119], v[118:119], v[38:39]
    v_pk_mul_f32 v[104:105], v[104:105], s[82:83] op_sel_hi:[1,0]
    v_pk_mul_f32 v[106:107], v[106:107], s[82:83] op_sel_hi:[1,0]
    v_pk_mul_f32 v[108:109], v[108:109], s[82:83] op_sel_hi:[1,0]
    v_pk_mul_f32 v[110:111], v[110:111], s[82:83] op_sel_hi:[1,0]
    v_cvt_pk_bf16_f32 v104, v104, v105
    v_cvt_pk_bf16_f32 v105, v106, v107
    v_cvt_pk_bf16_f32 v106, v108, v109
    v_cvt_pk_bf16_f32 v107, v110, v111
    buffer_store_dwordx4 v[104:107], v23, s[36:39], s80 offen
    s_setprio 0
Rd3:
    ds_read_b32 v14, v15
    s_add_u32 s51, s51, 1
    s_cmp_lt_u32 s51, 3200000
    s_cbranch_scc0 Rd3c
    s_waitcnt lgkmcnt(0)
    v_cmp_gt_u32 vcc, 123, v14
    s_nop 0
    s_cbranch_vccnz Rd3
Rd3c:
    s_setprio 0
    ds_read_b128 v[56:59], v20 offset:32768
    ds_read_b128 v[60:63], v21 offset:32768
    ds_read_b128 v[64:67], v20 offset:40960
    ds_read_b128 v[68:71], v21 offset:40960
    ds_read_b128 v[72:75], v20 offset:49152
    ds_read_b128 v[76:79], v21 offset:49152
    ds_read_b128 v[80:83], v20 offset:57344
    ds_read_b128 v[84:87], v21 offset:57344
    s_waitcnt lgkmcnt(7)
    v_pk_add_f32 v[112:113], v[112:113], v[56:57]
    v_pk_add_f32 v[114:115], v[114:115], v[58:59]
    s_waitcnt lgkmcnt(6)
    v_pk_add_f32 v[116:117], v[116:117], v[60:61]
    v_pk_add_f32 v[118:119], v[118:119], v[62:63]
    s_waitcnt lgkmcnt(5)
    v_pk_add_f32 v[112:113], v[112:113], v[64:65]
    v_pk_add_f32 v[114:115], v[114:115], v[66:67]
    s_waitcnt lgkmcnt(4)
    v_pk_add_f32 v[116:117], v[116:117], v[68:69]
    v_pk_add_f32 v[118:119], v[118:119], v[70:71]
    s_waitcnt lgkmcnt(3)
    v_pk_add_f32 v[112:113], v[112:113], v[72:73]
    v_pk_add_f32 v[114:115], v[114:115], v[74:75]
    s_waitcnt lgkmcnt(2)
    v_pk_add_f32 v[116:117], v[116:117], v[76:77]
    v_pk_add_f32 v[118:119], v[118:119], v[78:79]
    s_waitcnt lgkmcnt(1)
    v_pk_add_f32 v[112:113], v[112:113], v[80:81]
    v_pk_add_f32 v[114:115], v[114:115], v[82:83]
    s_waitcnt lgkmcnt(0)
    v_pk_add_f32 v[116:117], v[116:117], v[84:85]
    v_pk_add_f32 v[118:119], v[118:119], v[86:87]
    v_pk_mul_f32 v[112:113], v[112:113], s[82:83] op_sel_hi:[1,0]
    v_pk_mul_f32 v[114:115], v[114:115], s[82:83] op_sel_hi:[1,0]
    v_pk_mul_f32 v[116:117], v[116:117], s[82:83] op_sel_hi:[1,0]
    v_pk_mul_f32 v[118:119], v[118:119], s[82:83] op_sel_hi:[1,0]
    v_cvt_pk_bf16_f32 v112, v112, v113
    v_cvt_pk_bf16_f32 v113, v114, v115
    v_cvt_pk_bf16_f32 v114, v116, v117
    v_cvt_pk_bf16_f32 v115, v118, v119
    buffer_store_dwordx4 v[112:115], v23, s[36:39], s81 offen
    s_endpgm
LPATH:
    s_bitcmp0_b32 s45, 0
    s_cselect_b64 s[40:41], s[12:13], s[14:15]
    s_mov_b32 s42, 1835008
    s_mov_b32 s43, 0x20000
    s_lshl_b32 s47, s2, 1
    s_lshr_b32 s48, s45, 1
    s_add_u32 s47, s47, s48
    s_mul_i32 s47, s47, 3584
    v_min_u32 v6, 27, v1
    v_lshlrev_b32 v6, 7, v6
    buffer_load_dword v34, v6, s[40:43], s47 offen
    s_load_dword s56, s[20:21], 524288
    s_mov_b64 s[32:33], s[16:17]
    s_mov_b32 s35, 0x20000
    s_mov_b64 s[24:25], s[20:21]
    s_and_b32 s47, s2, 3
    s_lshl_b32 s47, s47, 1
    s_lshr_b32 s48, s45, 1
    s_add_u32 s47, s47, s48
    s_and_b32 s48, s45, 1
    s_mul_i32 s48, s48, s47
    s_cmp_lg_u32 s48, 0
    s_cselect_b32 s34, 1835008, 0
    s_cselect_b32 s26, 33554432, 0
    s_max_u32 s47, s47, 1
    s_sub_u32 s47, s47, 1
    s_lshr_b32 s48, s2, 2
    s_mul_i32 s48, s48, 7
    s_add_u32 s48, s48, s47
    s_lshl_b32 s48, s48, 12
    s_add_u32 s69, s48, 29360128
    s_and_b32 s48, s47, 1
    s_mul_i32 s48, s48, 14
    s_lshr_b32 s49, s47, 1
    s_add_u32 s48, s48, s49
    s_lshr_b32 s49, s2, 7
    s_cmp_eq_u32 s47, 6
    s_cselect_b32 s47, 14, 4
    s_mul_i32 s47, s47, s49
    s_add_u32 s48, s48, s47
    s_bfe_u32 s49, s2, 0x20002
    s_mul_i32 s49, s49, 28
    s_add_u32 s48, s48, s49
    s_lshl_b32 s48, s48, 14
    s_bfe_u32 s49, s2, 0x30004
    s_lshl_b32 s49, s49, 7
    s_add_u32 s65, s48, s49
    v_and_b32 v6, 1, v5
    v_lshlrev_b32 v6, 1, v6
    v_and_b32 v8, 7, v1
    v_xor_b32 v6, v6, v8
    v_lshrrev_b32 v7, 3, v1
    v_lshlrev_b32 v6, 4, v6
    v_lshl_add_u32 v40, v7, 10, v6
    v_xor_b32 v6, 64, v40
    v_add_u32 v41, 7168, v6
    v_add_u32 v42, 112640, v40
    v_add_u32 v43, 119808, v6
    s_lshl_b32 s64, s45, 15
    s_add_u32 m0, s64, 28672
    s_nop 0
    buffer_load_dwordx4 v40, s[32:35], s65 offen offset:0 lds
    buffer_load_dwordx4 v41, s[32:35], s65 offen offset:1024 lds
    buffer_load_dwordx4 v42, s[32:35], s65 offen offset:2048 lds
    buffer_load_dwordx4 v43, s[32:35], s65 offen offset:3072 lds
    s_mov_b64 s[28:29], s[20:21]
    s_mov_b64 s[72:73], s[6:7]
    s_mov_b64 s[76:77], s[8:9]
    s_mov_b32 s30, 33554432
    s_mov_b32 s31, 0x20000
    s_mov_b32 s74, 1052672
    s_mov_b32 s75, 0x20000
    s_mov_b32 s78, 1052672
    s_mov_b32 s79, 0x20000
    s_and_b32 s58, s46, 1
    s_bfe_u32 s47, s46, 0x40001
    s_mul_i32 s59, s47, 7
    s_mul_i32 s47, s58, 3
    s_add_u32 s59, s59, s47
    s_lshr_b32 s47, s46, 5
    s_lshl_b32 s47, s47, 3
    s_lshl_b32 s48, s45, 1
    s_add_u32 s47, s47, s48
    s_add_u32 s60, s47, s58
    s_xor_b32 s60, s60, 1
    s_and_b32 s66, s53, 1
    s_lshr_b32 s47, s53, 1
    s_lshl_b32 s47, s47, 2
    s_lshr_b32 s48, s54, 3
    s_add_u32 s61, s47, s48
    s_and_b32 s62, s54, 7
    s_mul_i32 s63, s46, 8320
    s_lshl_b32 s48, s45, 11
    s_add_u32 s63, s63, s48
    s_add_u32 s63, s63, 11534336
    v_and_b32 v6, 255, v0
    v_mul_u32_u24 v52, 4112, v6
    s_mul_i32 s47, s53, 514
    s_lshl_b32 s48, s54, 4
    s_add_u32 s47, s47, s48
    s_add_u32 s67, s47, 2
    s_lshl_b32 s68, s45, 10
    v_mov_b32 v56, -1
    v_mov_b32 v57, -1
    v_mov_b32 v58, -1
    v_mov_b32 v59, -1
    v_and_b32 v6, 1, v5
    v_bfe_u32 v7, v1, 3, 1
    v_lshl_add_u32 v7, v6, 1, v7
    v_bfe_u32 v8, v1, 2, 2
    v_lshlrev_b32 v6, 10, v5
    v_lshl_add_u32 v6, v8, 7, v6
    v_and_b32 v8, 3, v1
    v_lshl_add_u32 v6, v8, 3, v6
    v_add_u32 v6, s64, v6
    v_xor_b32 v8, 0, v7
    v_lshl_add_u32 v64, v8, 5, v6
    v_xor_b32 v8, 1, v7
    v_lshl_add_u32 v65, v8, 5, v6
    v_xor_b32 v8, 2, v7
    v_lshl_add_u32 v66, v8, 5, v6
    v_xor_b32 v8, 3, v7
    v_lshl_add_u32 v67, v8, 5, v6
    v_bfe_u32 v7, v1, 3, 1
    v_lshl_add_u32 v7, v5, 7, v7
    v_mul_u32_u24 v7, 3584, v7
    v_and_b32 v6, 1, v5
    v_lshlrev_b32 v6, 1, v6
    v_and_b32 v8, 7, v1
    v_xor_b32 v6, v6, v8
    s_and_b32 s47, s45, 1
    s_lshl_b32 s47, s47, 2
    v_xor_b32 v6, s47, v6
    v_xor_b32 v8, 4, v6
    s_lshr_b32 s47, s45, 1
    s_mul_i32 s48, s47, 229376
    s_lshl_b32 s47, s59, 5
    s_add_u32 s47, s47, s48
    v_add_u32 v7, s47, v7
    v_lshl_add_u32 v48, v6, 4, v7
    v_lshl_add_u32 v8, v8, 4, v7
    v_add_u32 v49, 6144, v8
    v_add_u32 v50, 12288, v48
    v_add_u32 v51, 18432, v8
    s_waitcnt lgkmcnt(0)
    s_bfe_u32 s47, s56, 0x2000d
    s_bfe_u32 s48, s56, 0x2001d
    s_lshl_b32 s47, 1, s47
    s_lshl_b32 s48, 1, s48
    s_or_b32 s47, s47, s48
    s_ff0_i32_b32 s56, s47
    s_mul_i32 s57, s56, 0x20002000
    v_mov_b32 v3, 1610637312
    s_setprio 0
    s_lshl_b32 s47, s45, 2
    s_add_u32 s47, s47, 157696
    v_mov_b32 v60, s47
Gt1:
    ds_read_b32 v61, v60
    s_add_u32 s51, s51, 1
    s_cmp_lt_u32 s51, 3200000
    s_cbranch_scc0 Gt1c
    s_waitcnt lgkmcnt(0)
    v_readfirstlane_b32 s47, v61
    s_nop 0
    s_bitcmp0_b32 131064, s47
    s_cbranch_scc1 Gt1
Gt1c:
    s_add_u32 m0, s68, 149504
    s_nop 0
    buffer_load_dwordx4 v52, s[72:75], s67 offen lds
    s_add_u32 m0, s68, 153600
    s_nop 0
    buffer_load_dwordx4 v52, s[76:79], s67 offen lds
    s_waitcnt vmcnt(2)
    ds_read_b64_tr_b16 v[72:73], v64 offset:28672
    ds_read_b64_tr_b16 v[74:75], v64 offset:29184
    ds_read_b64_tr_b16 v[76:77], v65 offset:28672
    ds_read_b64_tr_b16 v[78:79], v65 offset:29184
    ds_read_b64_tr_b16 v[80:81], v66 offset:28672
    ds_read_b64_tr_b16 v[82:83], v66 offset:29184
    ds_read_b64_tr_b16 v[84:85], v67 offset:28672
    ds_read_b64_tr_b16 v[86:87], v67 offset:29184
    s_waitcnt vmcnt(0)
    v_mov_b32 v11, 6
    ds_write_b32 v10, v11
Gt2:
    ds_read_b32 v61, v60
    s_add_u32 s51, s51, 1
    s_cmp_lt_u32 s51, 3200000
    s_cbranch_scc0 Gt2c
    s_waitcnt lgkmcnt(0)
    v_readfirstlane_b32 s47, v61
    s_nop 0
    s_bitcmp0_b32 131040, s47
    s_cbranch_scc1 Gt2
Gt2c:
    v_and_b32 v6, 1, v5
    v_bfe_u32 v7, v1, 3, 1
    v_lshl_add_u32 v7, v6, 1, v7
    v_bfe_u32 v8, v1, 2, 2
    v_lshlrev_b32 v6, 10, v5
    v_lshl_add_u32 v6, v8, 7, v6
    v_and_b32 v8, 3, v1
    v_lshl_add_u32 v6, v8, 3, v6
    s_add_u32 s47, s58, 0
    s_and_b32 s47, s47, 3
    v_xor_b32 v8, s47, v7
    v_lshl_add_u32 v16, v8, 5, v6
    s_add_u32 s47, s58, 1
    s_and_b32 s47, s47, 3
    v_xor_b32 v8, s47, v7
    v_lshl_add_u32 v17, v8, 5, v6
    s_add_u32 s47, s58, 2
    s_and_b32 s47, s47, 3
    v_xor_b32 v8, s47, v7
    v_lshl_add_u32 v18, v8, 5, v6
    s_add_u32 s47, s58, 3
    s_and_b32 s47, s47, 3
    v_xor_b32 v8, s47, v7
    v_lshl_add_u32 v19, v8, 5, v6
    v_bfe_u32 v6, v1, 3, 1
    v_mul_u32_u24 v6, 8320, v6
    v_and_b32 v8, 7, v1
    v_lshl_add_u32 v12, v5, 7, v6
    v_lshl_add_u32 v12, v8, 4, v12
    v_lshrrev_b32 v6, 1, v5
    v_mul_u32_u24 v6, 6144, v6
    v_lshl_add_u32 v6, v5, 9, v6
    v_lshl_add_u32 v13, v4, 4, v6
    s_mul_i32 s47, s60, 33280
    s_add_u32 s70, s47, 11534336
    s_add_u32 s71, s47, 11538432
    s_add_u32 s72, s47, 11550976
    s_add_u32 s73, s47, 11555072
    s_mul_i32 s48, s60, 112
    s_add_u32 s48, s48, s59
    s_add_u32 s47, s58, 0
    s_and_b32 s47, s47, 3
    s_add_u32 s47, s47, s48
    s_lshl_b32 s47, s47, 10
    s_add_u32 s74, s47, 16777216
    s_add_u32 s47, s58, 1
    s_and_b32 s47, s47, 3
    s_add_u32 s47, s47, s48
    s_lshl_b32 s47, s47, 10
    s_add_u32 s75, s47, 16777216
    s_add_u32 s47, s58, 2
    s_and_b32 s47, s47, 3
    s_add_u32 s47, s47, s48
    s_lshl_b32 s47, s47, 10
    s_add_u32 s76, s47, 16777216
    s_mov_b32 s67, 0x409d30fc
    s_mov_b32 s68, 0x6760ec05
    v_mov_b32 v0, v10
    s_lshl_b32 s47, s66, 3
    s_add_u32 s47, s47, s62
    s_lshl_b32 s47, s47, 2
    s_add_u32 s47, s47, s45
    s_mul_i32 s47, s47, 28672
    s_add_u32 s90, s47, 29360128
    v_mov_b32 v7, v5
    v_mov_b32 v8, v4
    v_and_b32 v6, 7, v1
    v_xor_b32 v20, v7, v6
    v_lshlrev_b32 v20, 4, v20
    v_lshl_add_u32 v20, v8, 8, v20
    s_lshl_b32 s47, s45, 13
    s_add_u32 s47, s47, 0x10000
    v_add_u32 v20, s47, v20
    v_xor_b32 v21, 64, v20
    v_and_b32 v22, 7, v1
    v_lshlrev_b32 v22, 2, v22
    v_add_u32 v22, 157696, v22
    s_mul_i32 s47, s61, 448
    s_mul_i32 s48, s45, 28
    s_add_u32 s47, s47, s48
    s_lshl_b32 s48, s66, 2
    s_add_u32 s47, s47, s48
    s_lshl_b32 s47, s47, 10
    s_mul_i32 s48, s66, 114688
    s_mul_i32 s49, s66, 10240
    s_add_u32 s78, s47, s48
    s_add_u32 s78, s78, 16777216
    s_add_u32 s79, s78, 14336
    s_add_u32 s80, s78, s49
    s_add_u32 s81, s47, s48
    s_add_u32 s81, s81, 17006592
    s_add_u32 s82, s81, 14336
    s_add_u32 s83, s81, s49
    s_sub_u32 s84, s47, s48
    s_add_u32 s84, s84, 16891904
    s_add_u32 s85, s84, 14336
    s_add_u32 s86, s84, s49
    s_sub_u32 s87, s47, s48
    s_add_u32 s87, s87, 17121280
    s_add_u32 s88, s87, 14336
    s_add_u32 s89, s87, s49
    buffer_store_dwordx4 v[56:59], v2, s[28:31], s63 offen offset:0 sc1
    buffer_store_dwordx4 v[56:59], v2, s[28:31], s63 offen offset:1024 sc1
Gt3:
    ds_read_b32 v61, v60
    s_add_u32 s51, s51, 1
    s_cmp_lt_u32 s51, 3200000
    s_cbranch_scc0 Gt3c
    s_waitcnt lgkmcnt(0)
    v_readfirstlane_b32 s47, v61
    s_nop 0
    s_bitcmp0_b32 131008, s47
    s_cbranch_scc1 Gt3
Gt3c:
    buffer_store_dwordx4 v[72:75], v2, s[24:27], s69 offen offset:0 sc1
    buffer_store_dwordx4 v[76:79], v2, s[24:27], s69 offen offset:1024 sc1
    buffer_store_dwordx4 v[80:83], v2, s[24:27], s69 offen offset:2048 sc1
    buffer_store_dwordx4 v[84:87], v2, s[24:27], s69 offen offset:3072 sc1
    s_add_u32 m0, s64, 0
    s_mov_b32 s65, 0
    buffer_load_dwordx4 v48, s[40:43], s65 offen offset:0 lds
    buffer_load_dwordx4 v49, s[40:43], s65 offen offset:1024 lds
    buffer_load_dwordx4 v50, s[40:43], s65 offen offset:2048 lds
    buffer_load_dwordx4 v51, s[40:43], s65 offen offset:3072 lds
    s_waitcnt vmcnt(4)
    v_mov_b32 v11, 100
    ds_write_b32 v10, v11
    s_add_u32 m0, s64, 4096
    s_mov_b32 s65, 28672
    buffer_load_dwordx4 v48, s[40:43], s65 offen offset:0 lds
Gt4:
    ds_read_b32 v61, v60
    s_add_u32 s51, s51, 1
    s_cmp_lt_u32 s51, 3200000
    s_cbranch_scc0 Gt4c
    s_waitcnt lgkmcnt(0)
    v_readfirstlane_b32 s47, v61
    s_nop 0
    s_bitcmp0_b32 105416, s47
    s_cbranch_scc1 Gt4
Gt4c:
    buffer_load_dwordx4 v49, s[40:43], s65 offen offset:1024 lds
Gt5:
    ds_read_b32 v61, v60
    s_add_u32 s51, s51, 1
    s_cmp_lt_u32 s51, 3200000
    s_cbranch_scc0 Gt5c
    s_waitcnt lgkmcnt(0)
    v_readfirstlane_b32 s47, v61
    s_nop 0
    s_bitcmp0_b32 105416, s47
    s_cbranch_scc1 Gt5
Gt5c:
    buffer_load_dwordx4 v50, s[40:43], s65 offen offset:2048 lds
Gt6:
    ds_read_b32 v61, v60
    s_add_u32 s51, s51, 1
    s_cmp_lt_u32 s51, 3200000
    s_cbranch_scc0 Gt6c
    s_waitcnt lgkmcnt(0)
    v_readfirstlane_b32 s47, v61
    s_nop 0
    s_bitcmp0_b32 105416, s47
    s_cbranch_scc1 Gt6
Gt6c:
    buffer_load_dwordx4 v51, s[40:43], s65 offen offset:3072 lds
Gt7:
    ds_read_b32 v61, v60
    s_add_u32 s51, s51, 1
    s_cmp_lt_u32 s51, 3200000
    s_cbranch_scc0 Gt7c
    s_waitcnt lgkmcnt(0)
    v_readfirstlane_b32 s47, v61
    s_nop 0
    s_bitcmp0_b32 105416, s47
    s_cbranch_scc1 Gt7
Gt7c:
    s_add_u32 m0, s64, 8192
    s_mov_b32 s65, 57344
    buffer_load_dwordx4 v48, s[40:43], s65 offen offset:0 lds
Gt8:
    ds_read_b32 v61, v60
    s_add_u32 s51, s51, 1
    s_cmp_lt_u32 s51, 3200000
    s_cbranch_scc0 Gt8c
    s_waitcnt lgkmcnt(0)
    v_readfirstlane_b32 s47, v61
    s_nop 0
    s_bitcmp0_b32 105416, s47
    s_cbranch_scc1 Gt8
Gt8c:
    buffer_load_dwordx4 v49, s[40:43], s65 offen offset:1024 lds
Gt9:
    ds_read_b32 v61, v60
    s_add_u32 s51, s51, 1
    s_cmp_lt_u32 s51, 3200000
    s_cbranch_scc0 Gt9c
    s_waitcnt lgkmcnt(0)
    v_readfirstlane_b32 s47, v61
    s_nop 0
    s_bitcmp0_b32 105416, s47
    s_cbranch_scc1 Gt9
Gt9c:
    buffer_load_dwordx4 v50, s[40:43], s65 offen offset:2048 lds
Gt10:
    ds_read_b32 v61, v60
    s_add_u32 s51, s51, 1
    s_cmp_lt_u32 s51, 3200000
    s_cbranch_scc0 Gt10c
    s_waitcnt lgkmcnt(0)
    v_readfirstlane_b32 s47, v61
    s_nop 0
    s_bitcmp0_b32 105416, s47
    s_cbranch_scc1 Gt10
Gt10c:
    buffer_load_dwordx4 v51, s[40:43], s65 offen offset:3072 lds
Gt11:
    ds_read_b32 v61, v60
    s_add_u32 s51, s51, 1
    s_cmp_lt_u32 s51, 3200000
    s_cbranch_scc0 Gt11c
    s_waitcnt lgkmcnt(0)
    v_readfirstlane_b32 s47, v61
    s_nop 0
    s_bitcmp0_b32 105416, s47
    s_cbranch_scc1 Gt11
Gt11c:
    s_add_u32 m0, s64, 12288
    s_mov_b32 s65, 86016
    buffer_load_dwordx4 v48, s[40:43], s65 offen offset:0 lds
Gt12:
    ds_read_b32 v61, v60
    s_add_u32 s51, s51, 1
    s_cmp_lt_u32 s51, 3200000
    s_cbranch_scc0 Gt12c
    s_waitcnt lgkmcnt(0)
    v_readfirstlane_b32 s47, v61
    s_nop 0
    s_bitcmp0_b32 105416, s47
    s_cbranch_scc1 Gt12
Gt12c:
    buffer_load_dwordx4 v49, s[40:43], s65 offen offset:1024 lds
Gt13:
    ds_read_b32 v61, v60
    s_add_u32 s51, s51, 1
    s_cmp_lt_u32 s51, 3200000
    s_cbranch_scc0 Gt13c
    s_waitcnt lgkmcnt(0)
    v_readfirstlane_b32 s47, v61
    s_nop 0
    s_bitcmp0_b32 105416, s47
    s_cbranch_scc1 Gt13
Gt13c:
    buffer_load_dwordx4 v50, s[40:43], s65 offen offset:2048 lds
Gt14:
    ds_read_b32 v61, v60
    s_add_u32 s51, s51, 1
    s_cmp_lt_u32 s51, 3200000
    s_cbranch_scc0 Gt14c
    s_waitcnt lgkmcnt(0)
    v_readfirstlane_b32 s47, v61
    s_nop 0
    s_bitcmp0_b32 105416, s47
    s_cbranch_scc1 Gt14
Gt14c:
    buffer_load_dwordx4 v51, s[40:43], s65 offen offset:3072 lds
Gt15:
    ds_read_b32 v61, v60
    s_add_u32 s51, s51, 1
    s_cmp_lt_u32 s51, 3200000
    s_cbranch_scc0 Gt15c
    s_waitcnt lgkmcnt(0)
    v_readfirstlane_b32 s47, v61
    s_nop 0
    s_bitcmp0_b32 105416, s47
    s_cbranch_scc1 Gt15
Gt15c:
    s_add_u32 m0, s64, 16384
    s_mov_b32 s65, 114688
    buffer_load_dwordx4 v48, s[40:43], s65 offen offset:0 lds
Gt16:
    ds_read_b32 v61, v60
    s_add_u32 s51, s51, 1
    s_cmp_lt_u32 s51, 3200000
    s_cbranch_scc0 Gt16c
    s_waitcnt lgkmcnt(0)
    v_readfirstlane_b32 s47, v61
    s_nop 0
    s_bitcmp0_b32 105416, s47
    s_cbranch_scc1 Gt16
Gt16c:
    buffer_load_dwordx4 v49, s[40:43], s65 offen offset:1024 lds
Gt17:
    ds_read_b32 v61, v60
    s_add_u32 s51, s51, 1
    s_cmp_lt_u32 s51, 3200000
    s_cbranch_scc0 Gt17c
    s_waitcnt lgkmcnt(0)
    v_readfirstlane_b32 s47, v61
    s_nop 0
    s_bitcmp0_b32 105416, s47
    s_cbranch_scc1 Gt17
Gt17c:
    buffer_load_dwordx4 v50, s[40:43], s65 offen offset:2048 lds
Gt18:
    ds_read_b32 v61, v60
    s_add_u32 s51, s51, 1
    s_cmp_lt_u32 s51, 3200000
    s_cbranch_scc0 Gt18c
    s_waitcnt lgkmcnt(0)
    v_readfirstlane_b32 s47, v61
    s_nop 0
    s_bitcmp0_b32 105416, s47
    s_cbranch_scc1 Gt18
Gt18c:
    buffer_load_dwordx4 v51, s[40:43], s65 offen offset:3072 lds
Gt19:
    ds_read_b32 v61, v60
    s_add_u32 s51, s51, 1
    s_cmp_lt_u32 s51, 3200000
    s_cbranch_scc0 Gt19c
    s_waitcnt lgkmcnt(0)
    v_readfirstlane_b32 s47, v61
    s_nop 0
    s_bitcmp0_b32 105416, s47
    s_cbranch_scc1 Gt19
Gt19c:
    s_waitcnt vmcnt(6)
    v_mov_b32 v11, 101
    ds_write_b32 v10, v11
Gt20:
    ds_read_b32 v61, v60
    s_add_u32 s51, s51, 1
    s_cmp_lt_u32 s51, 3200000
    s_cbranch_scc0 Gt20c
    s_waitcnt lgkmcnt(0)
    v_readfirstlane_b32 s47, v61
    s_nop 0
    s_bitcmp0_b32 129024, s47
    s_cbranch_scc1 Gt20
Gt20c:
    s_add_u32 m0, s64, 20480
    s_mov_b32 s65, 143360
    buffer_load_dwordx4 v48, s[40:43], s65 offen offset:0 lds
    buffer_load_dwordx4 v49, s[40:43], s65 offen offset:1024 lds
    buffer_load_dwordx4 v50, s[40:43], s65 offen offset:2048 lds
    buffer_load_dwordx4 v51, s[40:43], s65 offen offset:3072 lds
    s_add_u32 m0, s64, 24576
    s_mov_b32 s65, 172032
    buffer_load_dwordx4 v48, s[40:43], s65 offen offset:0 lds
    buffer_load_dwordx4 v49, s[40:43], s65 offen offset:1024 lds
    buffer_load_dwordx4 v50, s[40:43], s65 offen offset:2048 lds
    buffer_load_dwordx4 v51, s[40:43], s65 offen offset:3072 lds
    s_add_u32 m0, s64, 28672
    s_mov_b32 s65, 200704
    buffer_load_dwordx4 v48, s[40:43], s65 offen offset:0 lds
Gt21:
    ds_read_b32 v61, v60
    s_add_u32 s51, s51, 1
    s_cmp_lt_u32 s51, 3200000
    s_cbranch_scc0 Gt21c
    s_waitcnt lgkmcnt(0)
    v_readfirstlane_b32 s47, v61
    s_nop 0
    s_bitcmp0_b32 105416, s47
    s_cbranch_scc1 Gt21
Gt21c:
    buffer_load_dwordx4 v49, s[40:43], s65 offen offset:1024 lds
Gt22:
    ds_read_b32 v61, v60
    s_add_u32 s51, s51, 1
    s_cmp_lt_u32 s51, 3200000
    s_cbranch_scc0 Gt22c
    s_waitcnt lgkmcnt(0)
    v_readfirstlane_b32 s47, v61
    s_nop 0
    s_bitcmp0_b32 105416, s47
    s_cbranch_scc1 Gt22
Gt22c:
    buffer_load_dwordx4 v50, s[40:43], s65 offen offset:2048 lds
Gt23:
    ds_read_b32 v61, v60
    s_add_u32 s51, s51, 1
    s_cmp_lt_u32 s51, 3200000
    s_cbranch_scc0 Gt23c
    s_waitcnt lgkmcnt(0)
    v_readfirstlane_b32 s47, v61
    s_nop 0
    s_bitcmp0_b32 105416, s47
    s_cbranch_scc1 Gt23
Gt23c:
    buffer_load_dwordx4 v51, s[40:43], s65 offen offset:3072 lds
Gt24:
    ds_read_b32 v61, v60
    s_add_u32 s51, s51, 1
    s_cmp_lt_u32 s51, 3200000
    s_cbranch_scc0 Gt24c
    s_waitcnt lgkmcnt(0)
    v_readfirstlane_b32 s47, v61
    s_nop 0
    s_bitcmp0_b32 105416, s47
    s_cbranch_scc1 Gt24
Gt24c:
Aw:
    ds_read_b32 v61, v22
    s_add_u32 s51, s51, 1
    s_cmp_lt_u32 s51, 3200000
    s_cbranch_scc0 Awc
    s_waitcnt lgkmcnt(0)
    v_cmp_gt_u32 vcc, 12, v61
    s_nop 0
    s_cbranch_vccnz Aw
Awc:
Gt25:
    ds_read_b32 v61, v60
    s_add_u32 s51, s51, 1
    s_cmp_lt_u32 s51, 3200000
    s_cbranch_scc0 Gt25c
    s_waitcnt lgkmcnt(0)
    v_readfirstlane_b32 s47, v61
    s_nop 0
    s_bitcmp0_b32 105416, s47
    s_cbranch_scc1 Gt25
Gt25c:
    s_add_u32 s65, s90, 0
    buffer_load_dwordx4 a[0:3], v2, s[28:31], s65 offen offset:0 sc1
    buffer_load_dwordx4 a[4:7], v2, s[28:31], s65 offen offset:1024 sc1
Gt26:
    ds_read_b32 v61, v60
    s_add_u32 s51, s51, 1
    s_cmp_lt_u32 s51, 3200000
    s_cbranch_scc0 Gt26c
    s_waitcnt lgkmcnt(0)
    v_readfirstlane_b32 s47, v61
    s_nop 0
    s_bitcmp0_b32 105416, s47
    s_cbranch_scc1 Gt26
Gt26c:
    buffer_load_dwordx4 a[8:11], v2, s[28:31], s65 offen offset:2048 sc1
    s_waitcnt vmcnt(20)
    buffer_load_dwordx4 a[12:15], v2, s[28:31], s65 offen offset:3072 sc1
    s_waitcnt vmcnt(20)
Gt27:
    ds_read_b32 v61, v60
    s_add_u32 s51, s51, 1
    s_cmp_lt_u32 s51, 3200000
    s_cbranch_scc0 Gt27c
    s_waitcnt lgkmcnt(0)
    v_readfirstlane_b32 s47, v61
    s_nop 0
    s_bitcmp0_b32 105416, s47
    s_cbranch_scc1 Gt27
Gt27c:
    s_add_u32 s65, s90, 4096
    buffer_load_dwordx4 a[16:19], v2, s[28:31], s65 offen offset:0 sc1
    s_waitcnt vmcnt(20)
    buffer_load_dwordx4 a[20:23], v2, s[28:31], s65 offen offset:1024 sc1
    s_waitcnt vmcnt(20)
Gt28:
    ds_read_b32 v61, v60
    s_add_u32 s51, s51, 1
    s_cmp_lt_u32 s51, 3200000
    s_cbranch_scc0 Gt28c
    s_waitcnt lgkmcnt(0)
    v_readfirstlane_b32 s47, v61
    s_nop 0
    s_bitcmp0_b32 105416, s47
    s_cbranch_scc1 Gt28
Gt28c:
    buffer_load_dwordx4 a[24:27], v2, s[28:31], s65 offen offset:2048 sc1
    s_waitcnt vmcnt(20)
    buffer_load_dwordx4 a[28:31], v2, s[28:31], s65 offen offset:3072 sc1
    s_waitcnt vmcnt(20)
Gt29:
    ds_read_b32 v61, v60
    s_add_u32 s51, s51, 1
    s_cmp_lt_u32 s51, 3200000
    s_cbranch_scc0 Gt29c
    s_waitcnt lgkmcnt(0)
    v_readfirstlane_b32 s47, v61
    s_nop 0
    s_bitcmp0_b32 105416, s47
    s_cbranch_scc1 Gt29
Gt29c:
    s_add_u32 s65, s90, 8192
    buffer_load_dwordx4 a[32:35], v2, s[28:31], s65 offen offset:0 sc1
    s_waitcnt vmcnt(20)
    buffer_load_dwordx4 a[36:39], v2, s[28:31], s65 offen offset:1024 sc1
    s_waitcnt vmcnt(20)
Gt30:
    ds_read_b32 v61, v60
    s_add_u32 s51, s51, 1
    s_cmp_lt_u32 s51, 3200000
    s_cbranch_scc0 Gt30c
    s_waitcnt lgkmcnt(0)
    v_readfirstlane_b32 s47, v61
    s_nop 0
    s_bitcmp0_b32 105416, s47
    s_cbranch_scc1 Gt30
Gt30c:
    buffer_load_dwordx4 a[40:43], v2, s[28:31], s65 offen offset:2048 sc1
    s_waitcnt vmcnt(20)
    buffer_load_dwordx4 a[44:47], v2, s[28:31], s65 offen offset:3072 sc1
    s_waitcnt vmcnt(20)
Gt31:
    ds_read_b32 v61, v60
    s_add_u32 s51, s51, 1
    s_cmp_lt_u32 s51, 3200000
    s_cbranch_scc0 Gt31c
    s_waitcnt lgkmcnt(0)
    v_readfirstlane_b32 s47, v61
    s_nop 0
    s_bitcmp0_b32 105416, s47
    s_cbranch_scc1 Gt31
Gt31c:
    s_add_u32 s65, s90, 12288
    buffer_load_dwordx4 a[48:51], v2, s[28:31], s65 offen offset:0 sc1
    s_waitcnt vmcnt(20)
    buffer_load_dwordx4 a[52:55], v2, s[28:31], s65 offen offset:1024 sc1
    s_waitcnt vmcnt(20)
Gt32:
    ds_read_b32 v61, v60
    s_add_u32 s51, s51, 1
    s_cmp_lt_u32 s51, 3200000
    s_cbranch_scc0 Gt32c
    s_waitcnt lgkmcnt(0)
    v_readfirstlane_b32 s47, v61
    s_nop 0
    s_bitcmp0_b32 105416, s47
    s_cbranch_scc1 Gt32
Gt32c:
    buffer_load_dwordx4 a[56:59], v2, s[28:31], s65 offen offset:2048 sc1
    s_waitcnt vmcnt(20)
    buffer_load_dwordx4 a[60:63], v2, s[28:31], s65 offen offset:3072 sc1
    s_waitcnt vmcnt(20)
    s_waitcnt vmcnt(16)
    s_barrier
    s_setprio 2
Lw:
    ds_read_b32 v61, v22
    s_add_u32 s51, s51, 1
    s_cmp_lt_u32 s51, 3200000
    s_cbranch_scc0 Lwc
    s_waitcnt lgkmcnt(0)
    v_cmp_gt_u32 vcc, 17, v61
    s_nop 0
    s_cbranch_vccnz Lw
Lwc:
    buffer_load_dwordx4 v[72:75], v12, s[28:31], s70 offen offset:0 sc1
    s_waitcnt vmcnt(3)
    buffer_load_dwordx4 v[76:79], v12, s[28:31], s72 offen offset:0 sc1
    s_waitcnt vmcnt(3)
    s_add_u32 s65, s90, 16384
    buffer_load_dwordx4 a[64:67], v2, s[28:31], s65 offen offset:0 sc1
    s_waitcnt vmcnt(3)
    buffer_load_dwordx4 a[68:71], v2, s[28:31], s65 offen offset:1024 sc1
    s_waitcnt vmcnt(3)
    buffer_load_dwordx4 a[72:75], v2, s[28:31], s65 offen offset:2048 sc1
    s_waitcnt vmcnt(3)
    buffer_load_dwordx4 a[76:79], v2, s[28:31], s65 offen offset:3072 sc1
    s_waitcnt vmcnt(3)
    buffer_load_dwordx4 v[80:83], v12, s[28:31], s70 offen offset:512 sc1
    s_waitcnt vmcnt(3)
    buffer_load_dwordx4 v[84:87], v12, s[28:31], s72 offen offset:512 sc1
    s_waitcnt vmcnt(3)
    s_add_u32 s65, s90, 20480
    buffer_load_dwordx4 a[80:83], v2, s[28:31], s65 offen offset:0 sc1
    s_waitcnt vmcnt(3)
    buffer_load_dwordx4 a[84:87], v2, s[28:31], s65 offen offset:1024 sc1
    s_waitcnt vmcnt(3)
    buffer_load_dwordx4 a[88:91], v2, s[28:31], s65 offen offset:2048 sc1
    s_waitcnt vmcnt(3)
    buffer_load_dwordx4 a[92:95], v2, s[28:31], s65 offen offset:3072 sc1
    s_waitcnt vmcnt(3)
    buffer_load_dwordx4 v[88:91], v12, s[28:31], s70 offen offset:1024 sc1
    s_waitcnt vmcnt(3)
    buffer_load_dwordx4 v[92:95], v12, s[28:31], s72 offen offset:1024 sc1
    s_waitcnt vmcnt(3)
    s_add_u32 s65, s90, 24576
    buffer_load_dwordx4 a[96:99], v2, s[28:31], s65 offen offset:0 sc1
    s_waitcnt vmcnt(3)
    buffer_load_dwordx4 a[100:103], v2, s[28:31], s65 offen offset:1024 sc1
    s_waitcnt vmcnt(3)
    buffer_load_dwordx4 a[104:107], v2, s[28:31], s65 offen offset:2048 sc1
    s_waitcnt vmcnt(3)
    buffer_load_dwordx4 a[108:111], v2, s[28:31], s65 offen offset:3072 sc1
    s_waitcnt vmcnt(3)
    buffer_load_dwordx4 v[96:99], v12, s[28:31], s70 offen offset:1536 sc1
    s_waitcnt vmcnt(3)
    buffer_load_dwordx4 v[100:103], v12, s[28:31], s72 offen offset:1536 sc1
    s_waitcnt vmcnt(3)
    buffer_load_dwordx4 v[104:107], v12, s[28:31], s70 offen offset:2048 sc1
    s_waitcnt vmcnt(3)
    buffer_load_dwordx4 v[108:111], v12, s[28:31], s72 offen offset:2048 sc1
    s_waitcnt vmcnt(3)
    buffer_load_dwordx4 v[112:115], v12, s[28:31], s70 offen offset:2560 sc1
    s_waitcnt vmcnt(3)
    buffer_load_dwordx4 v[116:119], v12, s[28:31], s72 offen offset:2560 sc1
    s_waitcnt vmcnt(3)
    buffer_load_dwordx4 v[120:123], v12, s[28:31], s70 offen offset:3072 sc1
    s_waitcnt vmcnt(3)
    buffer_load_dwordx4 v[124:127], v12, s[28:31], s72 offen offset:3072 sc1
    s_waitcnt vmcnt(3)
    s_setprio 2
LSTART:
    ds_read_b64_tr_b16 a[112:113], v16 offset:0
    ds_read_b64_tr_b16 a[114:115], v16 offset:512
    ds_read_b64_tr_b16 a[116:117], v18 offset:32768
    ds_read_b64_tr_b16 a[118:119], v18 offset:33280
    ds_read_b64_tr_b16 a[120:121], v17 offset:0
    ds_read_b64_tr_b16 a[122:123], v17 offset:512
    v_max_u32 v14, v79, v75
    v_cmp_eq_u32 vcc, -1, v14
    s_nop 0
    s_cbranch_vccnz R_G1L0
C_G1L0:
    s_waitcnt lgkmcnt(4)
    v_mfma_f32_16x16x32_bf16 v[24:27], a[112:115], v[72:75], 0
    ds_read_b64_tr_b16 a[124:125], v19 offset:32768
    v_mfma_f32_16x16x32_bf16 v[28:31], a[112:115], v[76:79], 0
    ds_read_b64_tr_b16 a[126:127], v19 offset:33280
    s_waitcnt lgkmcnt(4)
    v_mfma_f32_16x16x32_bf16 v[32:35], a[116:119], v[72:75], 0
    ds_read_b64_tr_b16 a[112:113], v18 offset:0
    v_mfma_f32_16x16x32_bf16 v[36:39], a[116:119], v[76:79], 0
    ds_read_b64_tr_b16 a[114:115], v18 offset:512
    s_waitcnt lgkmcnt(4)
    v_mfma_f32_16x16x32_bf16 v[40:43], a[120:123], v[72:75], 0
    ds_read_b64_tr_b16 a[116:117], v16 offset:32768
    v_mfma_f32_16x16x32_bf16 v[44:47], a[120:123], v[76:79], 0
    ds_read_b64_tr_b16 a[118:119], v16 offset:33280
    s_waitcnt lgkmcnt(4)
    v_mfma_f32_16x16x32_bf16 v[48:51], a[124:127], v[72:75], 0
    ds_read_b64_tr_b16 a[120:121], v16 offset:4096
    v_max_u32 v14, v87, v83
    v_mfma_f32_16x16x32_bf16 v[52:55], a[124:127], v[76:79], 0
    ds_read_b64_tr_b16 a[122:123], v16 offset:4608
    s_waitcnt lgkmcnt(4)
    v_mfma_f32_16x16x32_bf16 v[56:59], a[112:115], v[72:75], 0
    ds_read_b64_tr_b16 a[124:125], v18 offset:36864
    v_cmp_eq_u32 vcc, -1, v14
    v_mfma_f32_16x16x32_bf16 v[60:63], a[112:115], v[76:79], 0
    ds_read_b64_tr_b16 a[126:127], v18 offset:37376
    s_waitcnt lgkmcnt(4)
    v_mfma_f32_16x16x32_bf16 v[64:67], a[116:119], v[72:75], 0
    ds_read_b64_tr_b16 a[112:113], v17 offset:4096
    s_cbranch_vccnz R_G1L1
C_G1L1:
    v_mfma_f32_16x16x32_bf16 v[68:71], a[116:119], v[76:79], 0
    ds_read_b64_tr_b16 a[114:115], v17 offset:4608
    s_waitcnt lgkmcnt(4)
    v_mfma_f32_16x16x32_bf16 v[24:27], a[120:123], v[80:83], v[24:27]
    ds_read_b64_tr_b16 a[116:117], v19 offset:36864
    buffer_load_dwordx4 v[72:75], v12, s[28:31], s70 offen offset:3584 sc1
    v_mfma_f32_16x16x32_bf16 v[28:31], a[120:123], v[84:87], v[28:31]
    ds_read_b64_tr_b16 a[118:119], v19 offset:37376
    s_waitcnt lgkmcnt(4)
    v_mfma_f32_16x16x32_bf16 v[32:35], a[124:127], v[80:83], v[32:35]
    ds_read_b64_tr_b16 a[120:121], v18 offset:4096
    buffer_load_dwordx4 v[76:79], v12, s[28:31], s72 offen offset:3584 sc1
    v_mfma_f32_16x16x32_bf16 v[36:39], a[124:127], v[84:87], v[36:39]
    ds_read_b64_tr_b16 a[122:123], v18 offset:4608
    s_waitcnt lgkmcnt(4)
    v_mfma_f32_16x16x32_bf16 v[40:43], a[112:115], v[80:83], v[40:43]
    ds_read_b64_tr_b16 a[124:125], v16 offset:36864
    v_mfma_f32_16x16x32_bf16 v[44:47], a[112:115], v[84:87], v[44:47]
    ds_read_b64_tr_b16 a[126:127], v16 offset:37376
    s_waitcnt lgkmcnt(4)
    v_mfma_f32_16x16x32_bf16 v[48:51], a[116:119], v[80:83], v[48:51]
    ds_read_b64_tr_b16 a[112:113], v16 offset:8192
    v_max_u32 v14, v95, v91
    v_mfma_f32_16x16x32_bf16 v[52:55], a[116:119], v[84:87], v[52:55]
    ds_read_b64_tr_b16 a[114:115], v16 offset:8704
    s_waitcnt lgkmcnt(4)
    v_mfma_f32_16x16x32_bf16 v[56:59], a[120:123], v[80:83], v[56:59]
    ds_read_b64_tr_b16 a[116:117], v18 offset:40960
    v_cmp_eq_u32 vcc, -1, v14
    v_mfma_f32_16x16x32_bf16 v[60:63], a[120:123], v[84:87], v[60:63]
    ds_read_b64_tr_b16 a[118:119], v18 offset:41472
    s_waitcnt lgkmcnt(4)
    v_mfma_f32_16x16x32_bf16 v[64:67], a[124:127], v[80:83], v[64:67]
    ds_read_b64_tr_b16 a[120:121], v17 offset:8192
    s_cbranch_vccnz R_G1L2
C_G1L2:
    v_mfma_f32_16x16x32_bf16 v[68:71], a[124:127], v[84:87], v[68:71]
    ds_read_b64_tr_b16 a[122:123], v17 offset:8704
    s_waitcnt lgkmcnt(4)
    v_mfma_f32_16x16x32_bf16 v[24:27], a[112:115], v[88:91], v[24:27]
    ds_read_b64_tr_b16 a[124:125], v19 offset:40960
    buffer_load_dwordx4 v[80:83], v12, s[28:31], s71 offen offset:0 sc1
    v_mfma_f32_16x16x32_bf16 v[28:31], a[112:115], v[92:95], v[28:31]
    ds_read_b64_tr_b16 a[126:127], v19 offset:41472
    s_waitcnt lgkmcnt(4)
    v_mfma_f32_16x16x32_bf16 v[32:35], a[116:119], v[88:91], v[32:35]
    ds_read_b64_tr_b16 a[112:113], v18 offset:8192
    buffer_load_dwordx4 v[84:87], v12, s[28:31], s73 offen offset:0 sc1
    v_mfma_f32_16x16x32_bf16 v[36:39], a[116:119], v[92:95], v[36:39]
    ds_read_b64_tr_b16 a[114:115], v18 offset:8704
    s_waitcnt lgkmcnt(4)
    v_mfma_f32_16x16x32_bf16 v[40:43], a[120:123], v[88:91], v[40:43]
    ds_read_b64_tr_b16 a[116:117], v16 offset:40960
    v_mfma_f32_16x16x32_bf16 v[44:47], a[120:123], v[92:95], v[44:47]
    ds_read_b64_tr_b16 a[118:119], v16 offset:41472
    s_waitcnt lgkmcnt(4)
    v_mfma_f32_16x16x32_bf16 v[48:51], a[124:127], v[88:91], v[48:51]
    ds_read_b64_tr_b16 a[120:121], v16 offset:12288
    v_max_u32 v14, v103, v99
    v_mfma_f32_16x16x32_bf16 v[52:55], a[124:127], v[92:95], v[52:55]
    ds_read_b64_tr_b16 a[122:123], v16 offset:12800
    s_waitcnt lgkmcnt(4)
    v_mfma_f32_16x16x32_bf16 v[56:59], a[112:115], v[88:91], v[56:59]
    ds_read_b64_tr_b16 a[124:125], v18 offset:45056
    v_cmp_eq_u32 vcc, -1, v14
    v_mfma_f32_16x16x32_bf16 v[60:63], a[112:115], v[92:95], v[60:63]
    ds_read_b64_tr_b16 a[126:127], v18 offset:45568
    s_waitcnt lgkmcnt(4)
    v_mfma_f32_16x16x32_bf16 v[64:67], a[116:119], v[88:91], v[64:67]
    ds_read_b64_tr_b16 a[112:113], v17 offset:12288
    s_cbranch_vccnz R_G1L3
C_G1L3:
    v_mfma_f32_16x16x32_bf16 v[68:71], a[116:119], v[92:95], v[68:71]
    ds_read_b64_tr_b16 a[114:115], v17 offset:12800
    s_waitcnt lgkmcnt(4)
    v_mfma_f32_16x16x32_bf16 v[24:27], a[120:123], v[96:99], v[24:27]
    ds_read_b64_tr_b16 a[116:117], v19 offset:45056
    buffer_load_dwordx4 v[88:91], v12, s[28:31], s71 offen offset:512 sc1
    v_mfma_f32_16x16x32_bf16 v[28:31], a[120:123], v[100:103], v[28:31]
    ds_read_b64_tr_b16 a[118:119], v19 offset:45568
    s_waitcnt lgkmcnt(4)
    v_mfma_f32_16x16x32_bf16 v[32:35], a[124:127], v[96:99], v[32:35]
    ds_read_b64_tr_b16 a[120:121], v18 offset:12288
    buffer_load_dwordx4 v[92:95], v12, s[28:31], s73 offen offset:512 sc1
    v_mfma_f32_16x16x32_bf16 v[36:39], a[124:127], v[100:103], v[36:39]
    ds_read_b64_tr_b16 a[122:123], v18 offset:12800
    s_waitcnt lgkmcnt(4)
    v_mfma_f32_16x16x32_bf16 v[40:43], a[112:115], v[96:99], v[40:43]
    ds_read_b64_tr_b16 a[124:125], v16 offset:45056
    v_mfma_f32_16x16x32_bf16 v[44:47], a[112:115], v[100:103], v[44:47]
    ds_read_b64_tr_b16 a[126:127], v16 offset:45568
    s_waitcnt lgkmcnt(4)
    v_mfma_f32_16x16x32_bf16 v[48:51], a[116:119], v[96:99], v[48:51]
    ds_read_b64_tr_b16 a[112:113], v16 offset:16384
    v_max_u32 v14, v111, v107
    v_mfma_f32_16x16x32_bf16 v[52:55], a[116:119], v[100:103], v[52:55]
    ds_read_b64_tr_b16 a[114:115], v16 offset:16896
    s_waitcnt lgkmcnt(4)
    v_mfma_f32_16x16x32_bf16 v[56:59], a[120:123], v[96:99], v[56:59]
    ds_read_b64_tr_b16 a[116:117], v18 offset:49152
    v_cmp_eq_u32 vcc, -1, v14
    v_mfma_f32_16x16x32_bf16 v[60:63], a[120:123], v[100:103], v[60:63]
    ds_read_b64_tr_b16 a[118:119], v18 offset:49664
    s_waitcnt lgkmcnt(4)
    v_mfma_f32_16x16x32_bf16 v[64:67], a[124:127], v[96:99], v[64:67]
    ds_read_b64_tr_b16 a[120:121], v17 offset:16384
    s_cbranch_vccnz R_G1L4
C_G1L4:
    v_mfma_f32_16x16x32_bf16 v[68:71], a[124:127], v[100:103], v[68:71]
    ds_read_b64_tr_b16 a[122:123], v17 offset:16896
    s_waitcnt lgkmcnt(4)
    v_mfma_f32_16x16x32_bf16 v[24:27], a[112:115], v[104:107], v[24:27]
    ds_read_b64_tr_b16 a[124:125], v19 offset:49152
    buffer_load_dwordx4 v[96:99], v12, s[28:31], s71 offen offset:1024 sc1
    v_mfma_f32_16x16x32_bf16 v[28:31], a[112:115], v[108:111], v[28:31]
    ds_read_b64_tr_b16 a[126:127], v19 offset:49664
    s_waitcnt lgkmcnt(4)
    v_mfma_f32_16x16x32_bf16 v[32:35], a[116:119], v[104:107], v[32:35]
    ds_read_b64_tr_b16 a[112:113], v18 offset:16384
    buffer_load_dwordx4 v[100:103], v12, s[28:31], s73 offen offset:1024 sc1
    v_mfma_f32_16x16x32_bf16 v[36:39], a[116:119], v[108:111], v[36:39]
    ds_read_b64_tr_b16 a[114:115], v18 offset:16896
    s_waitcnt lgkmcnt(4)
    v_mfma_f32_16x16x32_bf16 v[40:43], a[120:123], v[104:107], v[40:43]
    ds_read_b64_tr_b16 a[116:117], v16 offset:49152
    v_mfma_f32_16x16x32_bf16 v[44:47], a[120:123], v[108:111], v[44:47]
    ds_read_b64_tr_b16 a[118:119], v16 offset:49664
    s_waitcnt vmcnt(10) lgkmcnt(4)
    v_mfma_f32_16x16x32_bf16 v[48:51], a[124:127], v[104:107], v[48:51]
    ds_read_b64_tr_b16 a[120:121], v16 offset:20480
    v_max_u32 v14, v119, v115
    v_mfma_f32_16x16x32_bf16 v[52:55], a[124:127], v[108:111], v[52:55]
    ds_read_b64_tr_b16 a[122:123], v16 offset:20992
    s_waitcnt lgkmcnt(4)
    v_mfma_f32_16x16x32_bf16 v[56:59], a[112:115], v[104:107], v[56:59]
    ds_read_b64_tr_b16 a[124:125], v18 offset:53248
    v_cmp_eq_u32 vcc, -1, v14
    v_mfma_f32_16x16x32_bf16 v[60:63], a[112:115], v[108:111], v[60:63]
    ds_read_b64_tr_b16 a[126:127], v18 offset:53760
    s_waitcnt lgkmcnt(4)
    v_mfma_f32_16x16x32_bf16 v[64:67], a[116:119], v[104:107], v[64:67]
    ds_read_b64_tr_b16 a[112:113], v17 offset:20480
    s_cbranch_vccnz R_G1L5
C_G1L5:
    v_mfma_f32_16x16x32_bf16 v[68:71], a[116:119], v[108:111], v[68:71]
    ds_read_b64_tr_b16 a[114:115], v17 offset:20992
    s_waitcnt lgkmcnt(4)
    v_mfma_f32_16x16x32_bf16 v[24:27], a[120:123], v[112:115], v[24:27]
    ds_read_b64_tr_b16 a[116:117], v19 offset:53248
    buffer_load_dwordx4 v[104:107], v12, s[28:31], s71 offen offset:1536 sc1
    v_mfma_f32_16x16x32_bf16 v[28:31], a[120:123], v[116:119], v[28:31]
    ds_read_b64_tr_b16 a[118:119], v19 offset:53760
    s_waitcnt lgkmcnt(4)
    v_mfma_f32_16x16x32_bf16 v[32:35], a[124:127], v[112:115], v[32:35]
    ds_read_b64_tr_b16 a[120:121], v18 offset:20480
    buffer_load_dwordx4 v[108:111], v12, s[28:31], s73 offen offset:1536 sc1
    v_mfma_f32_16x16x32_bf16 v[36:39], a[124:127], v[116:119], v[36:39]
    ds_read_b64_tr_b16 a[122:123], v18 offset:20992
    s_waitcnt lgkmcnt(4)
    v_mfma_f32_16x16x32_bf16 v[40:43], a[112:115], v[112:115], v[40:43]
    ds_read_b64_tr_b16 a[124:125], v16 offset:53248
    v_mfma_f32_16x16x32_bf16 v[44:47], a[112:115], v[116:119], v[44:47]
    ds_read_b64_tr_b16 a[126:127], v16 offset:53760
    s_waitcnt vmcnt(10) lgkmcnt(4)
    v_mfma_f32_16x16x32_bf16 v[48:51], a[116:119], v[112:115], v[48:51]
    ds_read_b64_tr_b16 a[112:113], v16 offset:24576
    v_max_u32 v14, v127, v123
    v_mfma_f32_16x16x32_bf16 v[52:55], a[116:119], v[116:119], v[52:55]
    ds_read_b64_tr_b16 a[114:115], v16 offset:25088
    s_waitcnt lgkmcnt(4)
    v_mfma_f32_16x16x32_bf16 v[56:59], a[120:123], v[112:115], v[56:59]
    ds_read_b64_tr_b16 a[116:117], v18 offset:57344
    v_cmp_eq_u32 vcc, -1, v14
    v_mfma_f32_16x16x32_bf16 v[60:63], a[120:123], v[116:119], v[60:63]
    ds_read_b64_tr_b16 a[118:119], v18 offset:57856
    s_waitcnt lgkmcnt(4)
    v_mfma_f32_16x16x32_bf16 v[64:67], a[124:127], v[112:115], v[64:67]
    ds_read_b64_tr_b16 a[120:121], v17 offset:24576
    s_cbranch_vccnz R_G1L6
C_G1L6:
    v_mfma_f32_16x16x32_bf16 v[68:71], a[124:127], v[116:119], v[68:71]
    ds_read_b64_tr_b16 a[122:123], v17 offset:25088
    s_waitcnt lgkmcnt(4)
    v_mfma_f32_16x16x32_bf16 v[24:27], a[112:115], v[120:123], v[24:27]
    ds_read_b64_tr_b16 a[124:125], v19 offset:57344
    buffer_load_dwordx4 v[112:115], v12, s[28:31], s71 offen offset:2048 sc1
    v_mfma_f32_16x16x32_bf16 v[28:31], a[112:115], v[124:127], v[28:31]
    ds_read_b64_tr_b16 a[126:127], v19 offset:57856
    s_waitcnt lgkmcnt(4)
    v_mfma_f32_16x16x32_bf16 v[32:35], a[116:119], v[120:123], v[32:35]
    ds_read_b64_tr_b16 a[112:113], v18 offset:24576
    buffer_load_dwordx4 v[116:119], v12, s[28:31], s73 offen offset:2048 sc1
    v_mfma_f32_16x16x32_bf16 v[36:39], a[116:119], v[124:127], v[36:39]
    ds_read_b64_tr_b16 a[114:115], v18 offset:25088
    s_waitcnt lgkmcnt(4)
    v_mfma_f32_16x16x32_bf16 v[40:43], a[120:123], v[120:123], v[40:43]
    ds_read_b64_tr_b16 a[116:117], v16 offset:57344
    v_mfma_f32_16x16x32_bf16 v[44:47], a[120:123], v[124:127], v[44:47]
    ds_read_b64_tr_b16 a[118:119], v16 offset:57856
    s_waitcnt vmcnt(10) lgkmcnt(4)
    v_mfma_f32_16x16x32_bf16 v[48:51], a[124:127], v[120:123], v[48:51]
    ds_read_b64_tr_b16 a[120:121], v16 offset:28672
    v_max_u32 v14, v79, v75
    v_mfma_f32_16x16x32_bf16 v[52:55], a[124:127], v[124:127], v[52:55]
    ds_read_b64_tr_b16 a[122:123], v16 offset:29184
    s_waitcnt lgkmcnt(4)
    v_mfma_f32_16x16x32_bf16 v[56:59], a[112:115], v[120:123], v[56:59]
    ds_read_b64_tr_b16 a[124:125], v18 offset:61440
    v_cmp_eq_u32 vcc, -1, v14
    v_mfma_f32_16x16x32_bf16 v[60:63], a[112:115], v[124:127], v[60:63]
    ds_read_b64_tr_b16 a[126:127], v18 offset:61952
    s_waitcnt lgkmcnt(4)
    v_mfma_f32_16x16x32_bf16 v[64:67], a[116:119], v[120:123], v[64:67]
    ds_read_b64_tr_b16 a[112:113], v17 offset:28672
    s_cbranch_vccnz R_G1L7
C_G1L7:
    v_mfma_f32_16x16x32_bf16 v[68:71], a[116:119], v[124:127], v[68:71]
    ds_read_b64_tr_b16 a[114:115], v17 offset:29184
    s_waitcnt lgkmcnt(4)
    v_mfma_f32_16x16x32_bf16 v[24:27], a[120:123], v[72:75], v[24:27]
    ds_read_b64_tr_b16 a[116:117], v19 offset:61440
    buffer_load_dwordx4 v[120:123], v12, s[28:31], s71 offen offset:2560 sc1
    v_mfma_f32_16x16x32_bf16 v[28:31], a[120:123], v[76:79], v[28:31]
    ds_read_b64_tr_b16 a[118:119], v19 offset:61952
    s_waitcnt lgkmcnt(4)
    v_mfma_f32_16x16x32_bf16 v[32:35], a[124:127], v[72:75], v[32:35]
    ds_read_b64_tr_b16 a[120:121], v18 offset:28672
    buffer_load_dwordx4 v[124:127], v12, s[28:31], s73 offen offset:2560 sc1
    v_mfma_f32_16x16x32_bf16 v[36:39], a[124:127], v[76:79], v[36:39]
    ds_read_b64_tr_b16 a[122:123], v18 offset:29184
    s_waitcnt lgkmcnt(4)
    v_mfma_f32_16x16x32_bf16 v[40:43], a[112:115], v[72:75], v[40:43]
    ds_read_b64_tr_b16 a[124:125], v16 offset:61440
    v_mfma_f32_16x16x32_bf16 v[44:47], a[112:115], v[76:79], v[44:47]
    ds_read_b64_tr_b16 a[126:127], v16 offset:61952
    s_waitcnt vmcnt(10) lgkmcnt(4)
    v_mfma_f32_16x16x32_bf16 v[48:51], a[116:119], v[72:75], v[48:51]
    v_xor_b32 v16, 0x10000, v16
    ds_read_b64_tr_b16 a[112:113], v16 offset:0
    v_max_u32 v14, v87, v83
    v_mfma_f32_16x16x32_bf16 v[52:55], a[116:119], v[76:79], v[52:55]
    ds_read_b64_tr_b16 a[114:115], v16 offset:512
    s_waitcnt lgkmcnt(4)
    v_mfma_f32_16x16x32_bf16 v[56:59], a[120:123], v[72:75], v[56:59]
    v_xor_b32 v18, 0x10000, v18
    ds_read_b64_tr_b16 a[116:117], v18 offset:32768
    v_cmp_eq_u32 vcc, -1, v14
    v_mfma_f32_16x16x32_bf16 v[60:63], a[120:123], v[76:79], v[60:63]
    ds_read_b64_tr_b16 a[118:119], v18 offset:33280
    s_waitcnt lgkmcnt(4)
    v_mfma_f32_16x16x32_bf16 v[64:67], a[124:127], v[72:75], v[64:67]
    v_xor_b32 v17, 0x10000, v17
    ds_read_b64_tr_b16 a[120:121], v17 offset:0
    s_cbranch_vccnz R_G1L8
C_G1L8:
    v_mfma_f32_16x16x32_bf16 v[68:71], a[124:127], v[76:79], v[68:71]
    ds_read_b64_tr_b16 a[122:123], v17 offset:512
    s_waitcnt lgkmcnt(4)
    v_mfma_f32_16x16x32_bf16 v[24:27], a[112:115], v[80:83], v[24:27]
    v_xor_b32 v19, 0x10000, v19
    ds_read_b64_tr_b16 a[124:125], v19 offset:32768
    buffer_load_dwordx4 v[72:75], v12, s[28:31], s71 offen offset:3072 sc1
    v_mfma_f32_16x16x32_bf16 v[28:31], a[112:115], v[84:87], v[28:31]
    ds_read_b64_tr_b16 a[126:127], v19 offset:33280
    s_waitcnt lgkmcnt(4)
    v_mfma_f32_16x16x32_bf16 v[32:35], a[116:119], v[80:83], v[32:35]
    ds_read_b64_tr_b16 a[112:113], v18 offset:0
    buffer_load_dwordx4 v[76:79], v12, s[28:31], s73 offen offset:3072 sc1
    v_mfma_f32_16x16x32_bf16 v[36:39], a[116:119], v[84:87], v[36:39]
    ds_read_b64_tr_b16 a[114:115], v18 offset:512
    s_waitcnt lgkmcnt(4)
    v_mfma_f32_16x16x32_bf16 v[40:43], a[120:123], v[80:83], v[40:43]
    ds_read_b64_tr_b16 a[116:117], v16 offset:32768
    v_mfma_f32_16x16x32_bf16 v[44:47], a[120:123], v[84:87], v[44:47]
    ds_read_b64_tr_b16 a[118:119], v16 offset:33280
    s_waitcnt vmcnt(10) lgkmcnt(4)
    v_mfma_f32_16x16x32_bf16 v[48:51], a[124:127], v[80:83], v[48:51]
    ds_read_b64_tr_b16 a[120:121], v16 offset:4096
    v_max_u32 v14, v95, v91
    v_mfma_f32_16x16x32_bf16 v[52:55], a[124:127], v[84:87], v[52:55]
    ds_read_b64_tr_b16 a[122:123], v16 offset:4608
    s_waitcnt lgkmcnt(4)
    v_mfma_f32_16x16x32_bf16 v[56:59], a[112:115], v[80:83], v[56:59]
    ds_read_b64_tr_b16 a[124:125], v18 offset:36864
    v_cmp_eq_u32 vcc, -1, v14
    v_mfma_f32_16x16x32_bf16 v[60:63], a[112:115], v[84:87], v[60:63]
    ds_read_b64_tr_b16 a[126:127], v18 offset:37376
    s_waitcnt lgkmcnt(4)
    v_mfma_f32_16x16x32_bf16 v[64:67], a[116:119], v[80:83], v[64:67]
    ds_read_b64_tr_b16 a[112:113], v17 offset:4096
    s_cbranch_vccnz R_G1L9
C_G1L9:
    v_mfma_f32_16x16x32_bf16 v[68:71], a[116:119], v[84:87], v[68:71]
    ds_read_b64_tr_b16 a[114:115], v17 offset:4608
    s_waitcnt lgkmcnt(4)
    v_mfma_f32_16x16x32_bf16 v[24:27], a[120:123], v[88:91], v[24:27]
    ds_read_b64_tr_b16 a[116:117], v19 offset:36864
    buffer_load_dwordx4 v[80:83], v12, s[28:31], s71 offen offset:3584 sc1
    v_mfma_f32_16x16x32_bf16 v[28:31], a[120:123], v[92:95], v[28:31]
    ds_read_b64_tr_b16 a[118:119], v19 offset:37376
    s_waitcnt lgkmcnt(4)
    v_mfma_f32_16x16x32_bf16 v[32:35], a[124:127], v[88:91], v[32:35]
    ds_read_b64_tr_b16 a[120:121], v18 offset:4096
    buffer_load_dwordx4 v[84:87], v12, s[28:31], s73 offen offset:3584 sc1
    v_mfma_f32_16x16x32_bf16 v[36:39], a[124:127], v[92:95], v[36:39]
    ds_read_b64_tr_b16 a[122:123], v18 offset:4608
    s_waitcnt lgkmcnt(4)
    v_mfma_f32_16x16x32_bf16 v[40:43], a[112:115], v[88:91], v[40:43]
    ds_read_b64_tr_b16 a[124:125], v16 offset:36864
    v_mfma_f32_16x16x32_bf16 v[44:47], a[112:115], v[92:95], v[44:47]
    ds_read_b64_tr_b16 a[126:127], v16 offset:37376
    s_waitcnt vmcnt(10) lgkmcnt(4)
    v_mfma_f32_16x16x32_bf16 v[48:51], a[116:119], v[88:91], v[48:51]
    ds_read_b64_tr_b16 a[112:113], v16 offset:8192
    v_max_u32 v14, v103, v99
    v_mfma_f32_16x16x32_bf16 v[52:55], a[116:119], v[92:95], v[52:55]
    ds_read_b64_tr_b16 a[114:115], v16 offset:8704
    s_waitcnt lgkmcnt(4)
    v_mfma_f32_16x16x32_bf16 v[56:59], a[120:123], v[88:91], v[56:59]
    ds_read_b64_tr_b16 a[116:117], v18 offset:40960
    v_cmp_eq_u32 vcc, -1, v14
    v_mfma_f32_16x16x32_bf16 v[60:63], a[120:123], v[92:95], v[60:63]
    ds_read_b64_tr_b16 a[118:119], v18 offset:41472
    s_waitcnt lgkmcnt(4)
    v_mfma_f32_16x16x32_bf16 v[64:67], a[124:127], v[88:91], v[64:67]
    ds_read_b64_tr_b16 a[120:121], v17 offset:8192
    s_cbranch_vccnz R_G1L10
C_G1L10:
    v_mfma_f32_16x16x32_bf16 v[68:71], a[124:127], v[92:95], v[68:71]
    ds_read_b64_tr_b16 a[122:123], v17 offset:8704
    s_waitcnt lgkmcnt(4)
    v_mfma_f32_16x16x32_bf16 v[24:27], a[112:115], v[96:99], v[24:27]
    ds_read_b64_tr_b16 a[124:125], v19 offset:40960
    v_mfma_f32_16x16x32_bf16 v[28:31], a[112:115], v[100:103], v[28:31]
    ds_read_b64_tr_b16 a[126:127], v19 offset:41472
    s_waitcnt lgkmcnt(4)
    v_mfma_f32_16x16x32_bf16 v[32:35], a[116:119], v[96:99], v[32:35]
    ds_read_b64_tr_b16 a[112:113], v18 offset:8192
    v_mfma_f32_16x16x32_bf16 v[36:39], a[116:119], v[100:103], v[36:39]
    ds_read_b64_tr_b16 a[114:115], v18 offset:8704
    s_waitcnt lgkmcnt(4)
    v_mfma_f32_16x16x32_bf16 v[40:43], a[120:123], v[96:99], v[40:43]
    ds_read_b64_tr_b16 a[116:117], v16 offset:40960
    v_mfma_f32_16x16x32_bf16 v[44:47], a[120:123], v[100:103], v[44:47]
    ds_read_b64_tr_b16 a[118:119], v16 offset:41472
    s_waitcnt vmcnt(8) lgkmcnt(4)
    v_mfma_f32_16x16x32_bf16 v[48:51], a[124:127], v[96:99], v[48:51]
    ds_read_b64_tr_b16 a[120:121], v16 offset:12288
    v_max_u32 v14, v111, v107
    v_mfma_f32_16x16x32_bf16 v[52:55], a[124:127], v[100:103], v[52:55]
    ds_read_b64_tr_b16 a[122:123], v16 offset:12800
    s_waitcnt lgkmcnt(4)
    v_mfma_f32_16x16x32_bf16 v[56:59], a[112:115], v[96:99], v[56:59]
    ds_read_b64_tr_b16 a[124:125], v18 offset:45056
    v_cmp_eq_u32 vcc, -1, v14
    v_mfma_f32_16x16x32_bf16 v[60:63], a[112:115], v[100:103], v[60:63]
    ds_read_b64_tr_b16 a[126:127], v18 offset:45568
    s_waitcnt lgkmcnt(4)
    v_mfma_f32_16x16x32_bf16 v[64:67], a[116:119], v[96:99], v[64:67]
    ds_read_b64_tr_b16 a[112:113], v17 offset:12288
    s_cbranch_vccnz R_G1L11
C_G1L11:
    v_mfma_f32_16x16x32_bf16 v[68:71], a[116:119], v[100:103], v[68:71]
    ds_read_b64_tr_b16 a[114:115], v17 offset:12800
    s_waitcnt lgkmcnt(4)
    v_mfma_f32_16x16x32_bf16 v[24:27], a[120:123], v[104:107], v[24:27]
    ds_read_b64_tr_b16 a[116:117], v19 offset:45056
    buffer_load_dwordx4 v[4:7], v13, s[28:31], s78 offen offset:0 sc1
    v_mfma_f32_16x16x32_bf16 v[28:31], a[120:123], v[108:111], v[28:31]
    ds_read_b64_tr_b16 a[118:119], v19 offset:45568
    s_waitcnt lgkmcnt(4)
    v_mfma_f32_16x16x32_bf16 v[32:35], a[124:127], v[104:107], v[32:35]
    ds_read_b64_tr_b16 a[120:121], v18 offset:12288
    buffer_load_dwordx4 v[8:11], v13, s[28:31], s78 offen offset:256 sc1
    v_mfma_f32_16x16x32_bf16 v[36:39], a[124:127], v[108:111], v[36:39]
    ds_read_b64_tr_b16 a[122:123], v18 offset:12800
    s_waitcnt lgkmcnt(4)
    v_mfma_f32_16x16x32_bf16 v[40:43], a[112:115], v[104:107], v[40:43]
    ds_read_b64_tr_b16 a[124:125], v16 offset:45056
    v_mfma_f32_16x16x32_bf16 v[44:47], a[112:115], v[108:111], v[44:47]
    ds_read_b64_tr_b16 a[126:127], v16 offset:45568
    s_waitcnt vmcnt(8) lgkmcnt(4)
    v_mfma_f32_16x16x32_bf16 v[48:51], a[116:119], v[104:107], v[48:51]
    ds_read_b64_tr_b16 a[112:113], v16 offset:16384
    v_max_u32 v14, v119, v115
    v_mfma_f32_16x16x32_bf16 v[52:55], a[116:119], v[108:111], v[52:55]
    ds_read_b64_tr_b16 a[114:115], v16 offset:16896
    s_waitcnt lgkmcnt(4)
    v_mfma_f32_16x16x32_bf16 v[56:59], a[120:123], v[104:107], v[56:59]
    ds_read_b64_tr_b16 a[116:117], v18 offset:49152
    v_cmp_eq_u32 vcc, -1, v14
    v_mfma_f32_16x16x32_bf16 v[60:63], a[120:123], v[108:111], v[60:63]
    ds_read_b64_tr_b16 a[118:119], v18 offset:49664
    s_waitcnt lgkmcnt(4)
    v_mfma_f32_16x16x32_bf16 v[64:67], a[124:127], v[104:107], v[64:67]
    ds_read_b64_tr_b16 a[120:121], v17 offset:16384
    s_cbranch_vccnz R_G1L12
C_G1L12:
    v_mfma_f32_16x16x32_bf16 v[68:71], a[124:127], v[108:111], v[68:71]
    ds_read_b64_tr_b16 a[122:123], v17 offset:16896
    s_waitcnt lgkmcnt(4)
    v_mfma_f32_16x16x32_bf16 v[24:27], a[112:115], v[112:115], v[24:27]
    ds_read_b64_tr_b16 a[124:125], v19 offset:49152
    buffer_load_dwordx4 v[88:91], v13, s[28:31], s79 offen offset:0 sc1
    v_mfma_f32_16x16x32_bf16 v[28:31], a[112:115], v[116:119], v[28:31]
    ds_read_b64_tr_b16 a[126:127], v19 offset:49664
    s_waitcnt lgkmcnt(4)
    v_mfma_f32_16x16x32_bf16 v[32:35], a[116:119], v[112:115], v[32:35]
    ds_read_b64_tr_b16 a[112:113], v18 offset:16384
    buffer_load_dwordx4 v[92:95], v13, s[28:31], s79 offen offset:256 sc1
    v_mfma_f32_16x16x32_bf16 v[36:39], a[116:119], v[116:119], v[36:39]
    ds_read_b64_tr_b16 a[114:115], v18 offset:16896
    s_waitcnt lgkmcnt(4)
    v_mfma_f32_16x16x32_bf16 v[40:43], a[120:123], v[112:115], v[40:43]
    ds_read_b64_tr_b16 a[116:117], v16 offset:49152
    v_mfma_f32_16x16x32_bf16 v[44:47], a[120:123], v[116:119], v[44:47]
    ds_read_b64_tr_b16 a[118:119], v16 offset:49664
    s_waitcnt vmcnt(8) lgkmcnt(4)
    v_mfma_f32_16x16x32_bf16 v[48:51], a[124:127], v[112:115], v[48:51]
    ds_read_b64_tr_b16 a[120:121], v16 offset:20480
    v_max_u32 v14, v127, v123
    v_mfma_f32_16x16x32_bf16 v[52:55], a[124:127], v[116:119], v[52:55]
    ds_read_b64_tr_b16 a[122:123], v16 offset:20992
    s_waitcnt lgkmcnt(4)
    v_mfma_f32_16x16x32_bf16 v[56:59], a[112:115], v[112:115], v[56:59]
    ds_read_b64_tr_b16 a[124:125], v18 offset:53248
    v_cmp_eq_u32 vcc, -1, v14
    v_mfma_f32_16x16x32_bf16 v[60:63], a[112:115], v[116:119], v[60:63]
    ds_read_b64_tr_b16 a[126:127], v18 offset:53760
    s_waitcnt lgkmcnt(4)
    v_mfma_f32_16x16x32_bf16 v[64:67], a[116:119], v[112:115], v[64:67]
    ds_read_b64_tr_b16 a[112:113], v17 offset:20480
    s_cbranch_vccnz R_G1L13
C_G1L13:
    v_mfma_f32_16x16x32_bf16 v[68:71], a[116:119], v[116:119], v[68:71]
    ds_read_b64_tr_b16 a[114:115], v17 offset:20992
    s_waitcnt lgkmcnt(4)
    v_mfma_f32_16x16x32_bf16 v[24:27], a[120:123], v[120:123], v[24:27]
    ds_read_b64_tr_b16 a[116:117], v19 offset:53248
    buffer_load_dwordx4 v[96:99], v13, s[28:31], s78 offen offset:1024 sc1
    v_mfma_f32_16x16x32_bf16 v[28:31], a[120:123], v[124:127], v[28:31]
    ds_read_b64_tr_b16 a[118:119], v19 offset:53760
    s_waitcnt lgkmcnt(4)
    v_mfma_f32_16x16x32_bf16 v[32:35], a[124:127], v[120:123], v[32:35]
    ds_read_b64_tr_b16 a[120:121], v18 offset:20480
    buffer_load_dwordx4 v[100:103], v13, s[28:31], s78 offen offset:1280 sc1
    v_mfma_f32_16x16x32_bf16 v[36:39], a[124:127], v[124:127], v[36:39]
    ds_read_b64_tr_b16 a[122:123], v18 offset:20992
    s_waitcnt lgkmcnt(4)
    v_mfma_f32_16x16x32_bf16 v[40:43], a[112:115], v[120:123], v[40:43]
    ds_read_b64_tr_b16 a[124:125], v16 offset:53248
    v_mfma_f32_16x16x32_bf16 v[44:47], a[112:115], v[124:127], v[44:47]
    ds_read_b64_tr_b16 a[126:127], v16 offset:53760
    s_waitcnt vmcnt(8) lgkmcnt(4)
    v_mfma_f32_16x16x32_bf16 v[48:51], a[116:119], v[120:123], v[48:51]
    ds_read_b64_tr_b16 a[112:113], v16 offset:24576
    v_max_u32 v14, v79, v75
    v_mfma_f32_16x16x32_bf16 v[52:55], a[116:119], v[124:127], v[52:55]
    ds_read_b64_tr_b16 a[114:115], v16 offset:25088
    s_waitcnt lgkmcnt(4)
    v_mfma_f32_16x16x32_bf16 v[56:59], a[120:123], v[120:123], v[56:59]
    ds_read_b64_tr_b16 a[116:117], v18 offset:57344
    v_cmp_eq_u32 vcc, -1, v14
    v_mfma_f32_16x16x32_bf16 v[60:63], a[120:123], v[124:127], v[60:63]
    ds_read_b64_tr_b16 a[118:119], v18 offset:57856
    s_waitcnt lgkmcnt(4)
    v_mfma_f32_16x16x32_bf16 v[64:67], a[124:127], v[120:123], v[64:67]
    ds_read_b64_tr_b16 a[120:121], v17 offset:24576
    s_cbranch_vccnz R_G1L14
C_G1L14:
    v_mfma_f32_16x16x32_bf16 v[68:71], a[124:127], v[124:127], v[68:71]
    ds_read_b64_tr_b16 a[122:123], v17 offset:25088
    s_waitcnt lgkmcnt(4)
    v_mfma_f32_16x16x32_bf16 v[24:27], a[112:115], v[72:75], v[24:27]
    ds_read_b64_tr_b16 a[124:125], v19 offset:57344
    buffer_load_dwordx4 v[104:107], v13, s[28:31], s79 offen offset:1024 sc1
    v_mfma_f32_16x16x32_bf16 v[28:31], a[112:115], v[76:79], v[28:31]
    ds_read_b64_tr_b16 a[126:127], v19 offset:57856
    s_waitcnt lgkmcnt(4)
    v_mfma_f32_16x16x32_bf16 v[32:35], a[116:119], v[72:75], v[32:35]
    ds_read_b64_tr_b16 a[112:113], v18 offset:24576
    buffer_load_dwordx4 v[108:111], v13, s[28:31], s79 offen offset:1280 sc1
    v_mfma_f32_16x16x32_bf16 v[36:39], a[116:119], v[76:79], v[36:39]
    ds_read_b64_tr_b16 a[114:115], v18 offset:25088
    s_waitcnt lgkmcnt(4)
    v_mfma_f32_16x16x32_bf16 v[40:43], a[120:123], v[72:75], v[40:43]
    ds_read_b64_tr_b16 a[116:117], v16 offset:57344
    v_mfma_f32_16x16x32_bf16 v[44:47], a[120:123], v[76:79], v[44:47]
    ds_read_b64_tr_b16 a[118:119], v16 offset:57856
    s_waitcnt vmcnt(8) lgkmcnt(4)
    v_mfma_f32_16x16x32_bf16 v[48:51], a[124:127], v[72:75], v[48:51]
    ds_read_b64_tr_b16 a[120:121], v16 offset:28672
    v_max_u32 v14, v87, v83
    v_mfma_f32_16x16x32_bf16 v[52:55], a[124:127], v[76:79], v[52:55]
    ds_read_b64_tr_b16 a[122:123], v16 offset:29184
    s_waitcnt lgkmcnt(4)
    v_mfma_f32_16x16x32_bf16 v[56:59], a[112:115], v[72:75], v[56:59]
    ds_read_b64_tr_b16 a[124:125], v18 offset:61440
    v_cmp_eq_u32 vcc, -1, v14
    v_mfma_f32_16x16x32_bf16 v[60:63], a[112:115], v[76:79], v[60:63]
    ds_read_b64_tr_b16 a[126:127], v18 offset:61952
    s_waitcnt lgkmcnt(4)
    v_mfma_f32_16x16x32_bf16 v[64:67], a[116:119], v[72:75], v[64:67]
    ds_read_b64_tr_b16 a[112:113], v17 offset:28672
    s_cbranch_vccnz R_G1L15
C_G1L15:
    v_mfma_f32_16x16x32_bf16 v[68:71], a[116:119], v[76:79], v[68:71]
    ds_read_b64_tr_b16 a[114:115], v17 offset:29184
    s_waitcnt lgkmcnt(4)
    v_mfma_f32_16x16x32_bf16 v[24:27], a[120:123], v[80:83], v[24:27]
    ds_read_b64_tr_b16 a[116:117], v19 offset:61440
    buffer_load_dwordx4 v[112:115], v13, s[28:31], s81 offen offset:0 sc1
    v_mfma_f32_16x16x32_bf16 v[28:31], a[120:123], v[84:87], v[28:31]
    ds_read_b64_tr_b16 a[118:119], v19 offset:61952
    s_waitcnt lgkmcnt(4)
    v_mfma_f32_16x16x32_bf16 v[32:35], a[124:127], v[80:83], v[32:35]
    ds_read_b64_tr_b16 a[120:121], v18 offset:28672
    buffer_load_dwordx4 v[116:119], v13, s[28:31], s81 offen offset:256 sc1
    v_mfma_f32_16x16x32_bf16 v[36:39], a[124:127], v[84:87], v[36:39]
    ds_read_b64_tr_b16 a[122:123], v18 offset:29184
    s_waitcnt lgkmcnt(4)
    v_mfma_f32_16x16x32_bf16 v[40:43], a[112:115], v[80:83], v[40:43]
    ds_read_b64_tr_b16 a[124:125], v16 offset:61440
    v_mfma_f32_16x16x32_bf16 v[44:47], a[112:115], v[84:87], v[44:47]
    ds_read_b64_tr_b16 a[126:127], v16 offset:61952
    s_waitcnt lgkmcnt(4)
    v_mfma_f32_16x16x32_bf16 v[48:51], a[116:119], v[80:83], v[48:51]
    v_mfma_f32_16x16x32_bf16 v[52:55], a[116:119], v[84:87], v[52:55]
    s_waitcnt lgkmcnt(2)
    v_mfma_f32_16x16x32_bf16 v[56:59], a[120:123], v[80:83], v[56:59]
    v_mfma_f32_16x16x32_bf16 v[60:63], a[120:123], v[84:87], v[60:63]
    s_waitcnt lgkmcnt(0)
    v_mfma_f32_16x16x32_bf16 v[64:67], a[124:127], v[80:83], v[64:67]
    v_mfma_f32_16x16x32_bf16 v[68:71], a[124:127], v[84:87], v[68:71]
    s_setprio 2
    v_mov_b32 v16, 117
    ds_write_b32 v0, v16
    v_fma_f32 v12, v24, v24, s67
    buffer_load_dwordx4 v[120:123], v13, s[28:31], s82 offen offset:0 sc1
    v_fma_f32 v23, v25, v25, s67
    v_mul_f32 v32, v24, v32
    v_mul_f32 v33, v25, v33
    v_mul_f32 v24, -v24, v12
    v_mul_f32 v25, -v25, v23
    v_fma_f32 v12, v26, v26, s67
    v_fma_f32 v23, v27, v27, s67
    v_mul_f32 v34, v26, v34
    buffer_load_dwordx4 v[124:127], v13, s[28:31], s82 offen offset:256 sc1
    v_mul_f32 v35, v27, v35
    v_mul_f32 v26, -v26, v12
    v_mul_f32 v27, -v27, v23
    v_fma_f32 v12, v28, v28, s67
    v_fma_f32 v23, v29, v29, s67
    v_mul_f32 v36, v28, v36
    v_mul_f32 v37, v29, v37
    v_mul_f32 v28, -v28, v12
    buffer_load_dwordx4 a[112:115], v13, s[28:31], s78 offen offset:2048 sc1
    v_mul_f32 v29, -v29, v23
    v_fma_f32 v12, v30, v30, s67
    v_fma_f32 v23, v31, v31, s67
    v_mul_f32 v38, v30, v38
    v_mul_f32 v39, v31, v39
    v_mul_f32 v30, -v30, v12
    v_mul_f32 v31, -v31, v23
    v_exp_f32 v24, v24
    buffer_load_dwordx4 a[116:119], v13, s[28:31], s78 offen offset:2304 sc1
    v_exp_f32 v25, v25
    v_exp_f32 v26, v26
    v_exp_f32 v27, v27
    v_exp_f32 v28, v28
    v_exp_f32 v29, v29
    v_exp_f32 v30, v30
    v_exp_f32 v31, v31
    v_fma_f32 v24, v24, s68, s68
    buffer_load_dwordx4 a[120:123], v13, s[28:31], s79 offen offset:2048 sc1
    v_fma_f32 v25, v25, s68, s68
    v_fma_f32 v26, v26, s68, s68
    v_fma_f32 v27, v27, s68, s68
    v_fma_f32 v28, v28, s68, s68
    v_fma_f32 v29, v29, s68, s68
    v_fma_f32 v30, v30, s68, s68
    v_fma_f32 v31, v31, s68, s68
    v_rcp_f32 v24, v24
    buffer_load_dwordx4 a[124:127], v13, s[28:31], s79 offen offset:2304 sc1
    v_rcp_f32 v25, v25
    v_rcp_f32 v26, v26
    v_rcp_f32 v27, v27
    v_rcp_f32 v28, v28
    v_rcp_f32 v29, v29
    v_rcp_f32 v30, v30
    v_rcp_f32 v31, v31
    v_mul_f32 v32, v32, v24
    v_mul_f32 v33, v33, v25
    v_mul_f32 v34, v34, v26
    v_mul_f32 v35, v35, v27
    v_mul_f32 v36, v36, v28
    v_mul_f32 v37, v37, v29
    v_mul_f32 v38, v38, v30
    v_mul_f32 v39, v39, v31
    v_cvt_pk_bf16_f32 v24, v32, v33
    v_cvt_pk_bf16_f32 v26, v36, v37
    v_cvt_pk_bf16_f32 v25, v34, v35
    v_cvt_pk_bf16_f32 v27, v38, v39
    v_bfi_b32 v24, v3, s57, v24
    v_bfi_b32 v26, v3, s57, v26
    v_bfi_b32 v25, v3, s57, v25
    v_bfi_b32 v27, v3, s57, v27
    v_permlane16_swap_b32 v24, v26
    s_nop 0
    v_permlane16_swap_b32 v25, v27
    buffer_store_dwordx4 v[24:27], v2, s[28:31], s74 offen sc1
    v_fma_f32 v12, v40, v40, s67
    v_fma_f32 v23, v41, v41, s67
    v_mul_f32 v48, v40, v48
    v_mul_f32 v49, v41, v49
    v_mul_f32 v40, -v40, v12
    v_mul_f32 v41, -v41, v23
    v_fma_f32 v12, v42, v42, s67
    v_fma_f32 v23, v43, v43, s67
    v_mul_f32 v50, v42, v50
    v_mul_f32 v51, v43, v51
    v_mul_f32 v42, -v42, v12
    v_mul_f32 v43, -v43, v23
    v_fma_f32 v12, v44, v44, s67
    v_fma_f32 v23, v45, v45, s67
    v_mul_f32 v52, v44, v52
    v_mul_f32 v53, v45, v53
    v_mul_f32 v44, -v44, v12
    v_mul_f32 v45, -v45, v23
    v_fma_f32 v12, v46, v46, s67
    v_fma_f32 v23, v47, v47, s67
    v_mul_f32 v54, v46, v54
    v_mul_f32 v55, v47, v55
    v_mul_f32 v46, -v46, v12
    v_mul_f32 v47, -v47, v23
    v_exp_f32 v40, v40
    v_exp_f32 v41, v41
    v_exp_f32 v42, v42
    v_exp_f32 v43, v43
    v_exp_f32 v44, v44
    v_exp_f32 v45, v45
    v_exp_f32 v46, v46
    v_exp_f32 v47, v47
    v_fma_f32 v40, v40, s68, s68
    v_fma_f32 v41, v41, s68, s68
    v_fma_f32 v42, v42, s68, s68
    v_fma_f32 v43, v43, s68, s68
    v_fma_f32 v44, v44, s68, s68
    v_fma_f32 v45, v45, s68, s68
    v_fma_f32 v46, v46, s68, s68
    v_fma_f32 v47, v47, s68, s68
    v_rcp_f32 v40, v40
    v_rcp_f32 v41, v41
    v_rcp_f32 v42, v42
    v_rcp_f32 v43, v43
    v_rcp_f32 v44, v44
    v_rcp_f32 v45, v45
    v_rcp_f32 v46, v46
    v_rcp_f32 v47, v47
    v_mul_f32 v48, v48, v40
    v_mul_f32 v49, v49, v41
    v_mul_f32 v50, v50, v42
    v_mul_f32 v51, v51, v43
    v_mul_f32 v52, v52, v44
    v_mul_f32 v53, v53, v45
    v_mul_f32 v54, v54, v46
    v_mul_f32 v55, v55, v47
    v_cvt_pk_bf16_f32 v40, v48, v49
    v_cvt_pk_bf16_f32 v42, v52, v53
    v_cvt_pk_bf16_f32 v41, v50, v51
    v_cvt_pk_bf16_f32 v43, v54, v55
    v_bfi_b32 v40, v3, s57, v40
    v_bfi_b32 v42, v3, s57, v42
    v_bfi_b32 v41, v3, s57, v41
    v_bfi_b32 v43, v3, s57, v43
    v_permlane16_swap_b32 v40, v42
    s_nop 0
    v_permlane16_swap_b32 v41, v43
    buffer_store_dwordx4 v[40:43], v2, s[28:31], s75 offen sc1
    s_waitcnt vmcnt(14)
    v_xor_b32 v14, s57, v95
    v_bitop3_b32 v14, v14, v91, s57 bitop3:0xf6
    v_bitop3_b32 v14, v14, v11, s57 bitop3:0xf6
    v_bitop3_b32 v14, v14, v7, s57 bitop3:0xf6
    v_and_b32 v14, v3, v14
    v_cmp_ne_u32 vcc, 0, v14
    s_nop 0
    s_cbranch_vccnz R_G2_0
C_G2_0:
    v_mfma_f32_16x16x32_bf16 v[24:27], a[0:3], v[4:7], 0
    v_fma_f32 v12, v56, v56, s67
    v_fma_f32 v23, v57, v57, s67
    v_mul_f32 v64, v56, v64
    v_mfma_f32_16x16x32_bf16 v[72:75], a[0:3], v[8:11], 0
    v_mul_f32 v65, v57, v65
    v_mul_f32 v56, -v56, v12
    v_mul_f32 v57, -v57, v23
    v_mfma_f32_16x16x32_bf16 v[28:31], a[4:7], v[4:7], 0
    v_fma_f32 v12, v58, v58, s67
    v_fma_f32 v23, v59, v59, s67
    v_mfma_f32_16x16x32_bf16 v[76:79], a[4:7], v[8:11], 0
    v_mul_f32 v66, v58, v66
    v_mul_f32 v67, v59, v67
    v_mul_f32 v58, -v58, v12
    v_mfma_f32_16x16x32_bf16 v[32:35], a[8:11], v[4:7], 0
    v_mul_f32 v59, -v59, v23
    v_fma_f32 v12, v60, v60, s67
    v_mfma_f32_16x16x32_bf16 v[80:83], a[8:11], v[8:11], 0
    v_fma_f32 v23, v61, v61, s67
    v_mul_f32 v68, v60, v68
    v_mul_f32 v69, v61, v69
    v_mfma_f32_16x16x32_bf16 v[36:39], a[12:15], v[4:7], 0
    v_mul_f32 v60, -v60, v12
    v_mul_f32 v61, -v61, v23
    v_fma_f32 v12, v62, v62, s67
    v_mfma_f32_16x16x32_bf16 v[84:87], a[12:15], v[8:11], 0
    v_fma_f32 v23, v63, v63, s67
    v_mul_f32 v70, v62, v70
    v_mfma_f32_16x16x32_bf16 v[24:27], a[16:19], v[88:91], v[24:27]
    v_mul_f32 v71, v63, v71
    v_mul_f32 v62, -v62, v12
    v_mul_f32 v63, -v63, v23
    buffer_load_dwordx4 v[4:7], v13, s[28:31], s80 offen offset:3072 sc1
    v_mfma_f32_16x16x32_bf16 v[72:75], a[16:19], v[92:95], v[72:75]
    v_exp_f32 v56, v56
    s_waitcnt vmcnt(11)
    v_xor_b32 v14, s57, v111
    v_mfma_f32_16x16x32_bf16 v[28:31], a[20:23], v[88:91], v[28:31]
    v_exp_f32 v57, v57
    v_exp_f32 v58, v58
    buffer_load_dwordx4 v[8:11], v13, s[28:31], s80 offen offset:3328 sc1
    v_bitop3_b32 v14, v14, v107, s57 bitop3:0xf6
    v_mfma_f32_16x16x32_bf16 v[76:79], a[20:23], v[92:95], v[76:79]
    v_exp_f32 v59, v59
    v_bitop3_b32 v14, v14, v103, s57 bitop3:0xf6
    v_mfma_f32_16x16x32_bf16 v[32:35], a[24:27], v[88:91], v[32:35]
    v_exp_f32 v60, v60
    v_bitop3_b32 v14, v14, v99, s57 bitop3:0xf6
    v_mfma_f32_16x16x32_bf16 v[80:83], a[24:27], v[92:95], v[80:83]
    v_exp_f32 v61, v61
    v_exp_f32 v62, v62
    v_and_b32 v14, v3, v14
    v_mfma_f32_16x16x32_bf16 v[36:39], a[28:31], v[88:91], v[36:39]
    v_exp_f32 v63, v63
    v_cmp_ne_u32 vcc, 0, v14
    v_mfma_f32_16x16x32_bf16 v[84:87], a[28:31], v[92:95], v[84:87]
    v_fma_f32 v56, v56, s68, s68
    v_fma_f32 v57, v57, s68, s68
    s_cbranch_vccnz R_G2_2
C_G2_2:
    v_mfma_f32_16x16x32_bf16 v[24:27], a[32:35], v[96:99], v[24:27]
    v_fma_f32 v58, v58, s68, s68
    v_fma_f32 v59, v59, s68, s68
    v_fma_f32 v60, v60, s68, s68
    buffer_load_dwordx4 v[88:91], v13, s[28:31], s81 offen offset:1024 sc1
    v_mfma_f32_16x16x32_bf16 v[72:75], a[32:35], v[100:103], v[72:75]
    v_fma_f32 v61, v61, s68, s68
    v_fma_f32 v62, v62, s68, s68
    v_mfma_f32_16x16x32_bf16 v[28:31], a[36:39], v[96:99], v[28:31]
    v_fma_f32 v63, v63, s68, s68
    v_rcp_f32 v56, v56
    buffer_load_dwordx4 v[92:95], v13, s[28:31], s81 offen offset:1280 sc1
    v_mfma_f32_16x16x32_bf16 v[76:79], a[36:39], v[100:103], v[76:79]
    v_rcp_f32 v57, v57
    v_mfma_f32_16x16x32_bf16 v[32:35], a[40:43], v[96:99], v[32:35]
    v_rcp_f32 v58, v58
    v_rcp_f32 v59, v59
    v_mfma_f32_16x16x32_bf16 v[80:83], a[40:43], v[100:103], v[80:83]
    v_rcp_f32 v60, v60
    v_mfma_f32_16x16x32_bf16 v[36:39], a[44:47], v[96:99], v[36:39]
    v_rcp_f32 v61, v61
    v_mfma_f32_16x16x32_bf16 v[84:87], a[44:47], v[100:103], v[84:87]
    v_rcp_f32 v62, v62
    v_rcp_f32 v63, v63
    v_mfma_f32_16x16x32_bf16 v[24:27], a[48:51], v[104:107], v[24:27]
    v_mul_f32 v64, v64, v56
    buffer_load_dwordx4 v[96:99], v13, s[28:31], s82 offen offset:1024 sc1
    v_mfma_f32_16x16x32_bf16 v[72:75], a[48:51], v[108:111], v[72:75]
    v_mul_f32 v65, v65, v57
    v_mul_f32 v66, v66, v58
    v_mul_f32 v67, v67, v59
    s_waitcnt vmcnt(11)
    v_xor_b32 v14, s57, v127
    v_mfma_f32_16x16x32_bf16 v[28:31], a[52:55], v[104:107], v[28:31]
    v_mul_f32 v68, v68, v60
    v_mul_f32 v69, v69, v61
    v_mul_f32 v70, v70, v62
    buffer_load_dwordx4 v[100:103], v13, s[28:31], s82 offen offset:1280 sc1
    v_bitop3_b32 v14, v14, v123, s57 bitop3:0xf6
    v_mfma_f32_16x16x32_bf16 v[76:79], a[52:55], v[108:111], v[76:79]
    v_mul_f32 v71, v71, v63
    v_cvt_pk_bf16_f32 v56, v64, v65
    v_bitop3_b32 v14, v14, v119, s57 bitop3:0xf6
    v_mfma_f32_16x16x32_bf16 v[32:35], a[56:59], v[104:107], v[32:35]
    v_cvt_pk_bf16_f32 v58, v68, v69
    v_cvt_pk_bf16_f32 v57, v66, v67
    v_cvt_pk_bf16_f32 v59, v70, v71
    v_bitop3_b32 v14, v14, v115, s57 bitop3:0xf6
    v_mfma_f32_16x16x32_bf16 v[80:83], a[56:59], v[108:111], v[80:83]
    v_bfi_b32 v56, v3, s57, v56
    v_bfi_b32 v58, v3, s57, v58
    v_and_b32 v14, v3, v14
    v_mfma_f32_16x16x32_bf16 v[36:39], a[60:63], v[104:107], v[36:39]
    v_bfi_b32 v57, v3, s57, v57
    v_bfi_b32 v59, v3, s57, v59
    v_permlane16_swap_b32 v56, v58
    v_cmp_ne_u32 vcc, 0, v14
    v_mfma_f32_16x16x32_bf16 v[84:87], a[60:63], v[108:111], v[84:87]
    v_permlane16_swap_b32 v57, v59
    buffer_store_dwordx4 v[56:59], v2, s[28:31], s76 offen sc1
    s_cbranch_vccnz R_G2_4
C_G2_4:
    v_mfma_f32_16x16x32_bf16 v[40:43], a[0:3], v[112:115], 0
    ds_read_b32 v17, v22
    buffer_load_dwordx4 v[104:107], v13, s[28:31], s81 offen offset:2048 sc1
    v_mfma_f32_16x16x32_bf16 v[56:59], a[0:3], v[116:119], 0
    v_mfma_f32_16x16x32_bf16 v[44:47], a[4:7], v[112:115], 0
    buffer_load_dwordx4 v[108:111], v13, s[28:31], s81 offen offset:2304 sc1
    v_mfma_f32_16x16x32_bf16 v[60:63], a[4:7], v[116:119], 0
    s_waitcnt vmcnt(7)
    v_xor_b32 v14, s57, v11
    v_mfma_f32_16x16x32_bf16 v[48:51], a[8:11], v[112:115], 0
    s_waitcnt lgkmcnt(0)
    v_cmp_gt_u32 vcc, 117, v17
    v_bitop3_b32 v14, v14, v7, s57 bitop3:0xf6
    v_mfma_f32_16x16x32_bf16 v[64:67], a[8:11], v[116:119], 0
    s_cbranch_vccnz YG117r
YG117c:
    v_accvgpr_read_b32 v15, a127
    v_mfma_f32_16x16x32_bf16 v[52:55], a[12:15], v[112:115], 0
    v_bitop3_b32 v14, v14, v15, s57 bitop3:0xf6
    v_mfma_f32_16x16x32_bf16 v[68:71], a[12:15], v[116:119], 0
    v_accvgpr_read_b32 v15, a123
    v_mfma_f32_16x16x32_bf16 v[40:43], a[16:19], v[120:123], v[40:43]
    buffer_load_dwordx4 v[112:115], v13, s[28:31], s82 offen offset:2048 sc1
    v_bitop3_b32 v14, v14, v15, s57 bitop3:0xf6
    v_mfma_f32_16x16x32_bf16 v[56:59], a[16:19], v[124:127], v[56:59]
    v_accvgpr_read_b32 v15, a119
    v_mfma_f32_16x16x32_bf16 v[44:47], a[20:23], v[120:123], v[44:47]
    buffer_load_dwordx4 v[116:119], v13, s[28:31], s82 offen offset:2304 sc1
    v_bitop3_b32 v14, v14, v15, s57 bitop3:0xf6
    v_mfma_f32_16x16x32_bf16 v[60:63], a[20:23], v[124:127], v[60:63]
    v_accvgpr_read_b32 v15, a115
    v_mfma_f32_16x16x32_bf16 v[48:51], a[24:27], v[120:123], v[48:51]
    v_bitop3_b32 v14, v14, v15, s57 bitop3:0xf6
    v_mfma_f32_16x16x32_bf16 v[64:67], a[24:27], v[124:127], v[64:67]
    v_and_b32 v14, v3, v14
    v_mfma_f32_16x16x32_bf16 v[52:55], a[28:31], v[120:123], v[52:55]
    v_cmp_ne_u32 vcc, 0, v14
    v_mfma_f32_16x16x32_bf16 v[68:71], a[28:31], v[124:127], v[68:71]
    s_cbranch_vccnz R_G2_6
C_G2_6:
    v_mfma_f32_16x16x32_bf16 v[24:27], a[64:67], a[112:115], v[24:27]
    buffer_load_dwordx4 v[120:123], v13, s[28:31], s83 offen offset:3072 sc1
    v_mfma_f32_16x16x32_bf16 v[24:27], a[80:83], a[120:123], v[24:27]
    v_mfma_f32_16x16x32_bf16 v[24:27], a[96:99], v[4:7], v[24:27]
    buffer_load_dwordx4 v[124:127], v13, s[28:31], s83 offen offset:3328 sc1
    v_mfma_f32_16x16x32_bf16 v[72:75], a[64:67], a[116:119], v[72:75]
    v_mfma_f32_16x16x32_bf16 v[72:75], a[80:83], a[124:127], v[72:75]
    v_mfma_f32_16x16x32_bf16 v[72:75], a[96:99], v[8:11], v[72:75]
    v_mfma_f32_16x16x32_bf16 v[28:31], a[68:71], a[112:115], v[28:31]
    v_mfma_f32_16x16x32_bf16 v[28:31], a[84:87], a[120:123], v[28:31]
    v_mfma_f32_16x16x32_bf16 v[28:31], a[100:103], v[4:7], v[28:31]
    s_nop 0
    ds_write_b128 v20, v[24:27] offset:0
    v_mfma_f32_16x16x32_bf16 v[76:79], a[68:71], a[116:119], v[76:79]
    v_mfma_f32_16x16x32_bf16 v[76:79], a[84:87], a[124:127], v[76:79]
    v_mfma_f32_16x16x32_bf16 v[76:79], a[100:103], v[8:11], v[76:79]
    ds_write_b128 v20, v[72:75] offset:4096
    v_mfma_f32_16x16x32_bf16 v[32:35], a[72:75], a[112:115], v[32:35]
    v_mfma_f32_16x16x32_bf16 v[32:35], a[88:91], a[120:123], v[32:35]
    v_mfma_f32_16x16x32_bf16 v[32:35], a[104:107], v[4:7], v[32:35]
    ds_write_b128 v21, v[28:31] offset:0
    v_mfma_f32_16x16x32_bf16 v[80:83], a[72:75], a[116:119], v[80:83]
    v_mfma_f32_16x16x32_bf16 v[80:83], a[88:91], a[124:127], v[80:83]
    v_mfma_f32_16x16x32_bf16 v[80:83], a[104:107], v[8:11], v[80:83]
    s_waitcnt vmcnt(7)
    v_xor_b32 v14, s57, v103
    ds_write_b128 v21, v[76:79] offset:4096
    v_mfma_f32_16x16x32_bf16 v[36:39], a[76:79], a[112:115], v[36:39]
    v_bitop3_b32 v14, v14, v99, s57 bitop3:0xf6
    v_mfma_f32_16x16x32_bf16 v[36:39], a[92:95], a[120:123], v[36:39]
    v_bitop3_b32 v14, v14, v95, s57 bitop3:0xf6
    v_mfma_f32_16x16x32_bf16 v[36:39], a[108:111], v[4:7], v[36:39]
    v_bitop3_b32 v14, v14, v91, s57 bitop3:0xf6
    ds_write_b128 v20, v[32:35] offset:128
    v_mfma_f32_16x16x32_bf16 v[84:87], a[76:79], a[116:119], v[84:87]
    v_and_b32 v14, v3, v14
    v_mfma_f32_16x16x32_bf16 v[84:87], a[92:95], a[124:127], v[84:87]
    v_cmp_ne_u32 vcc, 0, v14
    v_mfma_f32_16x16x32_bf16 v[84:87], a[108:111], v[8:11], v[84:87]
    s_cbranch_vccnz R_G2_9
C_G2_9:
    ds_write_b128 v20, v[80:83] offset:4224
    v_mfma_f32_16x16x32_bf16 v[40:43], a[32:35], v[88:91], v[40:43]
    buffer_load_dwordx4 a[112:115], v13, s[28:31], s86 offen offset:3072 sc1
    v_mfma_f32_16x16x32_bf16 v[56:59], a[32:35], v[92:95], v[56:59]
    buffer_load_dwordx4 a[116:119], v13, s[28:31], s86 offen offset:3328 sc1
    v_mfma_f32_16x16x32_bf16 v[44:47], a[36:39], v[88:91], v[44:47]
    buffer_load_dwordx4 a[120:123], v13, s[28:31], s84 offen offset:0 sc1
    ds_write_b128 v21, v[36:39] offset:128
    v_mfma_f32_16x16x32_bf16 v[60:63], a[36:39], v[92:95], v[60:63]
    buffer_load_dwordx4 a[124:127], v13, s[28:31], s84 offen offset:256 sc1
    v_mfma_f32_16x16x32_bf16 v[48:51], a[40:43], v[88:91], v[48:51]
    buffer_load_dwordx4 v[4:7], v13, s[28:31], s85 offen offset:0 sc1
    v_mfma_f32_16x16x32_bf16 v[64:67], a[40:43], v[92:95], v[64:67]
    ds_write_b128 v21, v[84:87] offset:4224
    v_mfma_f32_16x16x32_bf16 v[52:55], a[44:47], v[88:91], v[52:55]
    buffer_load_dwordx4 v[8:11], v13, s[28:31], s85 offen offset:256 sc1
    v_mov_b32 v16, 120
    v_mfma_f32_16x16x32_bf16 v[68:71], a[44:47], v[92:95], v[68:71]
    s_waitcnt vmcnt(6)
    v_xor_b32 v14, s57, v127
    ds_write_b32 v0, v16
    v_mfma_f32_16x16x32_bf16 v[40:43], a[48:51], v[96:99], v[40:43]
    buffer_load_dwordx4 v[88:91], v13, s[28:31], s84 offen offset:1024 sc1
    v_bitop3_b32 v14, v14, v123, s57 bitop3:0xf6
    v_mfma_f32_16x16x32_bf16 v[56:59], a[48:51], v[100:103], v[56:59]
    v_bitop3_b32 v14, v14, v119, s57 bitop3:0xf6
    v_mfma_f32_16x16x32_bf16 v[44:47], a[52:55], v[96:99], v[44:47]
    buffer_load_dwordx4 v[92:95], v13, s[28:31], s84 offen offset:1280 sc1
    v_bitop3_b32 v14, v14, v115, s57 bitop3:0xf6
    v_mfma_f32_16x16x32_bf16 v[60:63], a[52:55], v[100:103], v[60:63]
    v_bitop3_b32 v14, v14, v111, s57 bitop3:0xf6
    v_mfma_f32_16x16x32_bf16 v[48:51], a[56:59], v[96:99], v[48:51]
    v_bitop3_b32 v14, v14, v107, s57 bitop3:0xf6
    v_mfma_f32_16x16x32_bf16 v[64:67], a[56:59], v[100:103], v[64:67]
    v_and_b32 v14, v3, v14
    v_mfma_f32_16x16x32_bf16 v[52:55], a[60:63], v[96:99], v[52:55]
    v_cmp_ne_u32 vcc, 0, v14
    v_mfma_f32_16x16x32_bf16 v[68:71], a[60:63], v[100:103], v[68:71]
    s_cbranch_vccnz R_G2_11
C_G2_11:
    v_mfma_f32_16x16x32_bf16 v[40:43], a[64:67], v[104:107], v[40:43]
    buffer_load_dwordx4 v[96:99], v13, s[28:31], s85 offen offset:1024 sc1
    v_mfma_f32_16x16x32_bf16 v[40:43], a[80:83], v[112:115], v[40:43]
    v_mfma_f32_16x16x32_bf16 v[40:43], a[96:99], v[120:123], v[40:43]
    buffer_load_dwordx4 v[100:103], v13, s[28:31], s85 offen offset:1280 sc1
    v_mfma_f32_16x16x32_bf16 v[56:59], a[64:67], v[108:111], v[56:59]
    v_mfma_f32_16x16x32_bf16 v[56:59], a[80:83], v[116:119], v[56:59]
    v_mfma_f32_16x16x32_bf16 v[56:59], a[96:99], v[124:127], v[56:59]
    v_mfma_f32_16x16x32_bf16 v[44:47], a[68:71], v[104:107], v[44:47]
    v_mfma_f32_16x16x32_bf16 v[44:47], a[84:87], v[112:115], v[44:47]
    v_mfma_f32_16x16x32_bf16 v[44:47], a[100:103], v[120:123], v[44:47]
    s_nop 0
    ds_write_b128 v20, v[40:43] offset:32768
    v_mfma_f32_16x16x32_bf16 v[60:63], a[68:71], v[108:111], v[60:63]
    v_mfma_f32_16x16x32_bf16 v[60:63], a[84:87], v[116:119], v[60:63]
    v_mfma_f32_16x16x32_bf16 v[60:63], a[100:103], v[124:127], v[60:63]
    ds_write_b128 v20, v[56:59] offset:36864
    v_mfma_f32_16x16x32_bf16 v[48:51], a[72:75], v[104:107], v[48:51]
    v_mfma_f32_16x16x32_bf16 v[48:51], a[88:91], v[112:115], v[48:51]
    s_waitcnt vmcnt(6)
    v_accvgpr_read_b32 v15, a127
    v_mfma_f32_16x16x32_bf16 v[48:51], a[104:107], v[120:123], v[48:51]
    v_xor_b32 v14, s57, v15
    ds_write_b128 v21, v[44:47] offset:32768
    v_mfma_f32_16x16x32_bf16 v[64:67], a[72:75], v[108:111], v[64:67]
    v_accvgpr_read_b32 v15, a123
    v_mfma_f32_16x16x32_bf16 v[64:67], a[88:91], v[116:119], v[64:67]
    v_bitop3_b32 v14, v14, v15, s57 bitop3:0xf6
    v_mfma_f32_16x16x32_bf16 v[64:67], a[104:107], v[124:127], v[64:67]
    v_accvgpr_read_b32 v15, a119
    ds_write_b128 v21, v[60:63] offset:36864
    v_mfma_f32_16x16x32_bf16 v[52:55], a[76:79], v[104:107], v[52:55]
    v_bitop3_b32 v14, v14, v15, s57 bitop3:0xf6
    v_mfma_f32_16x16x32_bf16 v[52:55], a[92:95], v[112:115], v[52:55]
    v_accvgpr_read_b32 v15, a115
    v_mfma_f32_16x16x32_bf16 v[52:55], a[108:111], v[120:123], v[52:55]
    v_bitop3_b32 v14, v14, v15, s57 bitop3:0xf6
    ds_write_b128 v20, v[48:51] offset:32896
    v_mfma_f32_16x16x32_bf16 v[68:71], a[76:79], v[108:111], v[68:71]
    v_and_b32 v14, v3, v14
    v_mfma_f32_16x16x32_bf16 v[68:71], a[92:95], v[116:119], v[68:71]
    v_cmp_ne_u32 vcc, 0, v14
    v_mfma_f32_16x16x32_bf16 v[68:71], a[108:111], v[124:127], v[68:71]
    s_cbranch_vccnz R_G2_14
C_G2_14:
    ds_write_b128 v20, v[64:67] offset:36992
    v_mfma_f32_16x16x32_bf16 v[24:27], a[96:99], a[112:115], 0
    buffer_load_dwordx4 v[104:107], v13, s[28:31], s84 offen offset:2048 sc1
    v_mfma_f32_16x16x32_bf16 v[72:75], a[96:99], a[116:119], 0
    buffer_load_dwordx4 v[108:111], v13, s[28:31], s84 offen offset:2304 sc1
    v_mfma_f32_16x16x32_bf16 v[28:31], a[100:103], a[112:115], 0
    buffer_load_dwordx4 v[112:115], v13, s[28:31], s85 offen offset:2048 sc1
    ds_write_b128 v21, v[52:55] offset:32896
    v_mfma_f32_16x16x32_bf16 v[76:79], a[100:103], a[116:119], 0
    v_mfma_f32_16x16x32_bf16 v[32:35], a[104:107], a[112:115], 0
    buffer_load_dwordx4 v[116:119], v13, s[28:31], s85 offen offset:2304 sc1
    v_mfma_f32_16x16x32_bf16 v[80:83], a[104:107], a[116:119], 0
    ds_write_b128 v21, v[68:71] offset:36992
    v_mfma_f32_16x16x32_bf16 v[36:39], a[108:111], a[112:115], 0
    buffer_load_dwordx4 v[120:123], v13, s[28:31], s89 offen offset:3072 sc1
    v_mov_b32 v16, 121
    v_mfma_f32_16x16x32_bf16 v[84:87], a[108:111], a[116:119], 0
    ds_write_b32 v0, v16
    v_mfma_f32_16x16x32_bf16 v[24:27], a[0:3], a[120:123], v[24:27]
    buffer_load_dwordx4 v[124:127], v13, s[28:31], s89 offen offset:3328 sc1
    buffer_load_dwordx4 a[112:115], v13, s[28:31], s87 offen offset:0 sc1
    v_mfma_f32_16x16x32_bf16 v[72:75], a[0:3], a[124:127], v[72:75]
    s_waitcnt vmcnt(9)
    v_xor_b32 v14, s57, v95
    v_mfma_f32_16x16x32_bf16 v[28:31], a[4:7], a[120:123], v[28:31]
    buffer_load_dwordx4 a[116:119], v13, s[28:31], s87 offen offset:256 sc1
    v_bitop3_b32 v14, v14, v91, s57 bitop3:0xf6
    v_mfma_f32_16x16x32_bf16 v[76:79], a[4:7], a[124:127], v[76:79]
    v_bitop3_b32 v14, v14, v11, s57 bitop3:0xf6
    v_mfma_f32_16x16x32_bf16 v[32:35], a[8:11], a[120:123], v[32:35]
    v_bitop3_b32 v14, v14, v7, s57 bitop3:0xf6
    v_mfma_f32_16x16x32_bf16 v[80:83], a[8:11], a[124:127], v[80:83]
    v_and_b32 v14, v3, v14
    v_mfma_f32_16x16x32_bf16 v[36:39], a[12:15], a[120:123], v[36:39]
    v_cmp_ne_u32 vcc, 0, v14
    v_mfma_f32_16x16x32_bf16 v[84:87], a[12:15], a[124:127], v[84:87]
    s_cbranch_vccnz R_G2_16
C_G2_16:
    v_mfma_f32_16x16x32_bf16 v[24:27], a[16:19], v[4:7], v[24:27]
    buffer_load_dwordx4 a[120:123], v13, s[28:31], s88 offen offset:0 sc1
    v_mfma_f32_16x16x32_bf16 v[72:75], a[16:19], v[8:11], v[72:75]
    v_mfma_f32_16x16x32_bf16 v[28:31], a[20:23], v[4:7], v[28:31]
    buffer_load_dwordx4 a[124:127], v13, s[28:31], s88 offen offset:256 sc1
    v_mfma_f32_16x16x32_bf16 v[76:79], a[20:23], v[8:11], v[76:79]
    v_mfma_f32_16x16x32_bf16 v[32:35], a[24:27], v[4:7], v[32:35]
    v_mfma_f32_16x16x32_bf16 v[80:83], a[24:27], v[8:11], v[80:83]
    v_mfma_f32_16x16x32_bf16 v[36:39], a[28:31], v[4:7], v[36:39]
    v_mfma_f32_16x16x32_bf16 v[84:87], a[28:31], v[8:11], v[84:87]
    s_waitcnt vmcnt(6)
    v_xor_b32 v14, s57, v119
    v_mfma_f32_16x16x32_bf16 v[24:27], a[32:35], v[88:91], v[24:27]
    buffer_load_dwordx4 v[4:7], v13, s[28:31], s87 offen offset:1024 sc1
    v_bitop3_b32 v14, v14, v115, s57 bitop3:0xf6
    v_mfma_f32_16x16x32_bf16 v[72:75], a[32:35], v[92:95], v[72:75]
    v_bitop3_b32 v14, v14, v111, s57 bitop3:0xf6
    v_mfma_f32_16x16x32_bf16 v[28:31], a[36:39], v[88:91], v[28:31]
    buffer_load_dwordx4 v[8:11], v13, s[28:31], s87 offen offset:1280 sc1
    v_bitop3_b32 v14, v14, v107, s57 bitop3:0xf6
    v_mfma_f32_16x16x32_bf16 v[76:79], a[36:39], v[92:95], v[76:79]
    v_bitop3_b32 v14, v14, v103, s57 bitop3:0xf6
    v_mfma_f32_16x16x32_bf16 v[32:35], a[40:43], v[88:91], v[32:35]
    v_bitop3_b32 v14, v14, v99, s57 bitop3:0xf6
    v_mfma_f32_16x16x32_bf16 v[80:83], a[40:43], v[92:95], v[80:83]
    v_and_b32 v14, v3, v14
    v_mfma_f32_16x16x32_bf16 v[36:39], a[44:47], v[88:91], v[36:39]
    v_cmp_ne_u32 vcc, 0, v14
    v_mfma_f32_16x16x32_bf16 v[84:87], a[44:47], v[92:95], v[84:87]
    s_cbranch_vccnz R_G2_18
C_G2_18:
    v_mfma_f32_16x16x32_bf16 v[24:27], a[48:51], v[96:99], v[24:27]
    buffer_load_dwordx4 v[88:91], v13, s[28:31], s88 offen offset:1024 sc1
    v_mfma_f32_16x16x32_bf16 v[24:27], a[64:67], v[104:107], v[24:27]
    v_xor_b32 v20, 0x10000, v20
    v_mfma_f32_16x16x32_bf16 v[24:27], a[80:83], v[112:115], v[24:27]
    buffer_load_dwordx4 v[92:95], v13, s[28:31], s88 offen offset:1280 sc1
    v_xor_b32 v21, 0x10000, v21
    v_mfma_f32_16x16x32_bf16 v[72:75], a[48:51], v[100:103], v[72:75]
    v_mfma_f32_16x16x32_bf16 v[72:75], a[64:67], v[108:111], v[72:75]
    v_mfma_f32_16x16x32_bf16 v[72:75], a[80:83], v[116:119], v[72:75]
    v_mfma_f32_16x16x32_bf16 v[28:31], a[52:55], v[96:99], v[28:31]
    v_mfma_f32_16x16x32_bf16 v[28:31], a[68:71], v[104:107], v[28:31]
    v_mfma_f32_16x16x32_bf16 v[28:31], a[84:87], v[112:115], v[28:31]
    ds_write_b128 v20, v[24:27] offset:0
    v_mfma_f32_16x16x32_bf16 v[76:79], a[52:55], v[100:103], v[76:79]
    v_mfma_f32_16x16x32_bf16 v[76:79], a[68:71], v[108:111], v[76:79]
    v_mfma_f32_16x16x32_bf16 v[76:79], a[84:87], v[116:119], v[76:79]
    s_nop 0
    ds_write_b128 v20, v[72:75] offset:4096
    v_mfma_f32_16x16x32_bf16 v[32:35], a[56:59], v[96:99], v[32:35]
    v_mfma_f32_16x16x32_bf16 v[32:35], a[72:75], v[104:107], v[32:35]
    v_mfma_f32_16x16x32_bf16 v[32:35], a[88:91], v[112:115], v[32:35]
    ds_write_b128 v21, v[28:31] offset:0
    v_mfma_f32_16x16x32_bf16 v[80:83], a[56:59], v[100:103], v[80:83]
    s_waitcnt vmcnt(6)
    v_accvgpr_read_b32 v15, a119
    v_mfma_f32_16x16x32_bf16 v[80:83], a[72:75], v[108:111], v[80:83]
    v_xor_b32 v14, s57, v15
    v_mfma_f32_16x16x32_bf16 v[80:83], a[88:91], v[116:119], v[80:83]
    v_accvgpr_read_b32 v15, a115
    ds_write_b128 v21, v[76:79] offset:4096
    v_mfma_f32_16x16x32_bf16 v[36:39], a[60:63], v[96:99], v[36:39]
    v_bitop3_b32 v14, v14, v15, s57 bitop3:0xf6
    v_mfma_f32_16x16x32_bf16 v[36:39], a[76:79], v[104:107], v[36:39]
    v_bitop3_b32 v14, v14, v127, s57 bitop3:0xf6
    v_mfma_f32_16x16x32_bf16 v[36:39], a[92:95], v[112:115], v[36:39]
    v_bitop3_b32 v14, v14, v123, s57 bitop3:0xf6
    ds_write_b128 v20, v[32:35] offset:128
    v_mfma_f32_16x16x32_bf16 v[84:87], a[60:63], v[100:103], v[84:87]
    v_and_b32 v14, v3, v14
    v_mfma_f32_16x16x32_bf16 v[84:87], a[76:79], v[108:111], v[84:87]
    v_cmp_ne_u32 vcc, 0, v14
    v_mfma_f32_16x16x32_bf16 v[84:87], a[92:95], v[116:119], v[84:87]
    s_cbranch_vccnz R_G2_21
C_G2_21:
    ds_write_b128 v20, v[80:83] offset:4224
    v_mfma_f32_16x16x32_bf16 v[40:43], a[96:99], v[120:123], 0
    buffer_load_dwordx4 v[96:99], v13, s[28:31], s87 offen offset:2048 sc1
    v_mfma_f32_16x16x32_bf16 v[56:59], a[96:99], v[124:127], 0
    v_mfma_f32_16x16x32_bf16 v[44:47], a[100:103], v[120:123], 0
    buffer_load_dwordx4 v[100:103], v13, s[28:31], s87 offen offset:2304 sc1
    ds_write_b128 v21, v[36:39] offset:128
    v_mfma_f32_16x16x32_bf16 v[60:63], a[100:103], v[124:127], 0
    v_mfma_f32_16x16x32_bf16 v[48:51], a[104:107], v[120:123], 0
    buffer_load_dwordx4 v[104:107], v13, s[28:31], s88 offen offset:2048 sc1
    v_mfma_f32_16x16x32_bf16 v[64:67], a[104:107], v[124:127], 0
    ds_write_b128 v21, v[84:87] offset:4224
    v_mfma_f32_16x16x32_bf16 v[52:55], a[108:111], v[120:123], 0
    buffer_load_dwordx4 v[108:111], v13, s[28:31], s88 offen offset:2304 sc1
    v_mov_b32 v16, 122
    v_mfma_f32_16x16x32_bf16 v[68:71], a[108:111], v[124:127], 0
    s_waitcnt vmcnt(6)
    v_xor_b32 v14, s57, v11
    ds_write_b32 v0, v16
    v_mfma_f32_16x16x32_bf16 v[40:43], a[0:3], a[112:115], v[40:43]
    v_bitop3_b32 v14, v14, v7, s57 bitop3:0xf6
    v_mfma_f32_16x16x32_bf16 v[56:59], a[0:3], a[116:119], v[56:59]
    v_accvgpr_read_b32 v15, a127
    v_mfma_f32_16x16x32_bf16 v[44:47], a[4:7], a[112:115], v[44:47]
    v_bitop3_b32 v14, v14, v15, s57 bitop3:0xf6
    v_mfma_f32_16x16x32_bf16 v[60:63], a[4:7], a[116:119], v[60:63]
    v_accvgpr_read_b32 v15, a123
    v_mfma_f32_16x16x32_bf16 v[48:51], a[8:11], a[112:115], v[48:51]
    v_bitop3_b32 v14, v14, v15, s57 bitop3:0xf6
    v_mfma_f32_16x16x32_bf16 v[64:67], a[8:11], a[116:119], v[64:67]
    v_and_b32 v14, v3, v14
    v_mfma_f32_16x16x32_bf16 v[52:55], a[12:15], a[112:115], v[52:55]
    v_cmp_ne_u32 vcc, 0, v14
    v_mfma_f32_16x16x32_bf16 v[68:71], a[12:15], a[116:119], v[68:71]
    s_cbranch_vccnz R_G2_23
C_G2_23:
    v_mfma_f32_16x16x32_bf16 v[40:43], a[16:19], a[120:123], v[40:43]
    v_mfma_f32_16x16x32_bf16 v[56:59], a[16:19], a[124:127], v[56:59]
    v_mfma_f32_16x16x32_bf16 v[44:47], a[20:23], a[120:123], v[44:47]
    v_mfma_f32_16x16x32_bf16 v[60:63], a[20:23], a[124:127], v[60:63]
    v_mfma_f32_16x16x32_bf16 v[48:51], a[24:27], a[120:123], v[48:51]
    v_mfma_f32_16x16x32_bf16 v[64:67], a[24:27], a[124:127], v[64:67]
    v_mfma_f32_16x16x32_bf16 v[52:55], a[28:31], a[120:123], v[52:55]
    v_mfma_f32_16x16x32_bf16 v[68:71], a[28:31], a[124:127], v[68:71]
    s_waitcnt vmcnt(0)
    v_xor_b32 v14, s57, v111
    v_mfma_f32_16x16x32_bf16 v[40:43], a[32:35], v[4:7], v[40:43]
    v_bitop3_b32 v14, v14, v107, s57 bitop3:0xf6
    v_mfma_f32_16x16x32_bf16 v[56:59], a[32:35], v[8:11], v[56:59]
    v_bitop3_b32 v14, v14, v103, s57 bitop3:0xf6
    v_mfma_f32_16x16x32_bf16 v[44:47], a[36:39], v[4:7], v[44:47]
    v_bitop3_b32 v14, v14, v99, s57 bitop3:0xf6
    v_mfma_f32_16x16x32_bf16 v[60:63], a[36:39], v[8:11], v[60:63]
    v_bitop3_b32 v14, v14, v95, s57 bitop3:0xf6
    v_mfma_f32_16x16x32_bf16 v[48:51], a[40:43], v[4:7], v[48:51]
    v_bitop3_b32 v14, v14, v91, s57 bitop3:0xf6
    v_mfma_f32_16x16x32_bf16 v[64:67], a[40:43], v[8:11], v[64:67]
    v_and_b32 v14, v3, v14
    v_mfma_f32_16x16x32_bf16 v[52:55], a[44:47], v[4:7], v[52:55]
    v_cmp_ne_u32 vcc, 0, v14
    v_mfma_f32_16x16x32_bf16 v[68:71], a[44:47], v[8:11], v[68:71]
    s_cbranch_vccnz R_G2_25
C_G2_25:
    v_mfma_f32_16x16x32_bf16 v[40:43], a[48:51], v[88:91], v[40:43]
    v_mfma_f32_16x16x32_bf16 v[40:43], a[64:67], v[96:99], v[40:43]
    v_mfma_f32_16x16x32_bf16 v[40:43], a[80:83], v[104:107], v[40:43]
    v_mfma_f32_16x16x32_bf16 v[56:59], a[48:51], v[92:95], v[56:59]
    v_mfma_f32_16x16x32_bf16 v[56:59], a[64:67], v[100:103], v[56:59]
    v_mfma_f32_16x16x32_bf16 v[56:59], a[80:83], v[108:111], v[56:59]
    v_mfma_f32_16x16x32_bf16 v[44:47], a[52:55], v[88:91], v[44:47]
    v_mfma_f32_16x16x32_bf16 v[44:47], a[68:71], v[96:99], v[44:47]
    v_mfma_f32_16x16x32_bf16 v[44:47], a[84:87], v[104:107], v[44:47]
    s_nop 1
    ds_write_b128 v20, v[40:43] offset:32768
    v_mfma_f32_16x16x32_bf16 v[60:63], a[52:55], v[92:95], v[60:63]
    v_mfma_f32_16x16x32_bf16 v[60:63], a[68:71], v[100:103], v[60:63]
    v_mfma_f32_16x16x32_bf16 v[60:63], a[84:87], v[108:111], v[60:63]
    ds_write_b128 v20, v[56:59] offset:36864
    v_mfma_f32_16x16x32_bf16 v[48:51], a[56:59], v[88:91], v[48:51]
    v_mfma_f32_16x16x32_bf16 v[48:51], a[72:75], v[96:99], v[48:51]
    v_mfma_f32_16x16x32_bf16 v[48:51], a[88:91], v[104:107], v[48:51]
    ds_write_b128 v21, v[44:47] offset:32768
    v_mfma_f32_16x16x32_bf16 v[64:67], a[56:59], v[92:95], v[64:67]
    v_mfma_f32_16x16x32_bf16 v[64:67], a[72:75], v[100:103], v[64:67]
    v_mfma_f32_16x16x32_bf16 v[64:67], a[88:91], v[108:111], v[64:67]
    ds_write_b128 v21, v[60:63] offset:36864
    v_mfma_f32_16x16x32_bf16 v[52:55], a[60:63], v[88:91], v[52:55]
    v_mfma_f32_16x16x32_bf16 v[52:55], a[76:79], v[96:99], v[52:55]
    v_mfma_f32_16x16x32_bf16 v[52:55], a[92:95], v[104:107], v[52:55]
    ds_write_b128 v20, v[48:51] offset:32896
    v_mfma_f32_16x16x32_bf16 v[68:71], a[60:63], v[92:95], v[68:71]
    v_mfma_f32_16x16x32_bf16 v[68:71], a[76:79], v[100:103], v[68:71]
    v_mfma_f32_16x16x32_bf16 v[68:71], a[92:95], v[108:111], v[68:71]
    ds_write_b128 v20, v[64:67] offset:36992
    s_nop 2
    ds_write_b128 v21, v[52:55] offset:32896
    s_nop 2
    ds_write_b128 v21, v[68:71] offset:36992
    v_mov_b32 v16, 123
    ds_write_b32 v0, v16
    s_endpgm
WSr:
    v_and_b32 v8, 12, v12
    v_add_u32 v8, 157696, v8
WSl:
    ds_read_b32 v9, v8 offset:16
    ds_read_b32 v116, v15 offset:0
    ds_read_b32 v117, v15 offset:1024
    ds_read_b32 v118, v15 offset:2048
    ds_read_b32 v119, v15 offset:3072
    ds_read_b32 v120, v15 offset:4096
    ds_read_b32 v121, v15 offset:5120
    ds_read_b32 v122, v15 offset:6144
    ds_read_b32 v123, v15 offset:7168
    s_add_u32 s51, s51, 1
    s_cmp_lt_u32 s51, 3200000
    s_waitcnt lgkmcnt(0)
    s_cbranch_scc0 WSc
    v_cmp_gt_u32 vcc, 6, v9
    s_nop 0
    s_cbranch_vccnz WSl
    s_branch WSc
R_B:
    s_nop 3
    buffer_load_dwordx4 v[44:47], v18, s[28:31], s72 offen sc1
    buffer_load_dwordx4 v[48:51], v18, s[28:31], s73 offen sc1
    s_waitcnt vmcnt(0)
    v_xor_b32 v36, s57, v44
    v_xor_b32 v38, s57, v45
    v_xor_b32 v40, s57, v46
    v_xor_b32 v42, s57, v47
    v_or3_b32 v6, v36, v38, v40
    v_xor_b32 v37, s57, v48
    v_xor_b32 v39, s57, v49
    v_xor_b32 v41, s57, v50
    v_xor_b32 v43, s57, v51
    v_or3_b32 v7, v42, v37, v39
    v_or3_b32 v6, v6, v41, v43
    v_bitop3_b32 v6, v6, v7, v3 bitop3:0xa8
    v_cmp_ne_u32 vcc, 0, v6
    s_add_u32 s50, s50, 1
    s_cmp_gt_u32 s50, 400000
    s_cbranch_scc1 C_B
    s_cbranch_vccnz R_B
    s_branch C_B
R_C:
    s_nop 3
    buffer_load_dwordx4 v[44:47], v15, s[28:31], s72 offen sc1
    buffer_load_dwordx4 v[48:51], v15, s[28:31], s73 offen sc1
    s_waitcnt vmcnt(0)
    v_xor_b32 v36, s57, v44
    v_xor_b32 v38, s57, v45
    v_xor_b32 v40, s57, v46
    v_xor_b32 v42, s57, v47
    v_or3_b32 v6, v36, v38, v40
    v_xor_b32 v37, s57, v48
    v_xor_b32 v39, s57, v49
    v_xor_b32 v41, s57, v50
    v_xor_b32 v43, s57, v51
    v_or3_b32 v7, v42, v37, v39
    v_or3_b32 v6, v6, v41, v43
    v_bitop3_b32 v6, v6, v7, v3 bitop3:0xa8
    v_cmp_ne_u32 vcc, 0, v6
    s_add_u32 s50, s50, 1
    s_cmp_gt_u32 s50, 400000
    s_cbranch_scc1 C_C
    s_cbranch_vccnz R_C
    s_branch C_C
R_G1F0:
    s_nop 3
    buffer_load_dwordx4 v[88:91], v12, s[28:31], s68 offen offset:0 sc1
    buffer_load_dwordx4 v[92:95], v12, s[28:31], s70 offen offset:0 sc1
    buffer_load_dwordx4 v[96:99], v12, s[28:31], s68 offen offset:512 sc1
    buffer_load_dwordx4 v[100:103], v12, s[28:31], s70 offen offset:512 sc1
    s_waitcnt vmcnt(0)
    v_max_u32 v14, v95, v91
    v_cmp_eq_u32 vcc, -1, v14
    s_add_u32 s50, s50, 1
    s_cmp_gt_u32 s50, 400000
    s_cbranch_scc1 C_G1F0
    s_cbranch_vccnz R_G1F0
    s_branch C_G1F0
R_G1F1:
    s_nop 3
    buffer_load_dwordx4 v[96:99], v12, s[28:31], s68 offen offset:512 sc1
    buffer_load_dwordx4 v[100:103], v12, s[28:31], s70 offen offset:512 sc1
    buffer_load_dwordx4 v[104:107], v12, s[28:31], s68 offen offset:1024 sc1
    buffer_load_dwordx4 v[108:111], v12, s[28:31], s70 offen offset:1024 sc1
    buffer_load_dwordx4 v[112:115], v12, s[28:31], s68 offen offset:1536 sc1
    buffer_load_dwordx4 v[116:119], v12, s[28:31], s70 offen offset:1536 sc1
    s_waitcnt vmcnt(0)
    v_max_u32 v14, v103, v99
    v_cmp_eq_u32 vcc, -1, v14
    s_add_u32 s50, s50, 1
    s_cmp_gt_u32 s50, 400000
    s_cbranch_scc1 C_G1F1
    s_cbranch_vccnz R_G1F1
    s_branch C_G1F1
R_G1F2:
    s_nop 3
    buffer_load_dwordx4 v[104:107], v12, s[28:31], s68 offen offset:1024 sc1
    buffer_load_dwordx4 v[108:111], v12, s[28:31], s70 offen offset:1024 sc1
    buffer_load_dwordx4 v[112:115], v12, s[28:31], s68 offen offset:1536 sc1
    buffer_load_dwordx4 v[116:119], v12, s[28:31], s70 offen offset:1536 sc1
    buffer_load_dwordx4 v[120:123], v12, s[28:31], s68 offen offset:2048 sc1
    buffer_load_dwordx4 v[124:127], v12, s[28:31], s70 offen offset:2048 sc1
    buffer_load_dwordx4 v[88:91], v12, s[28:31], s68 offen offset:2560 sc1
    buffer_load_dwordx4 v[92:95], v12, s[28:31], s70 offen offset:2560 sc1
    s_waitcnt vmcnt(0)
    v_max_u32 v14, v111, v107
    v_cmp_eq_u32 vcc, -1, v14
    s_add_u32 s50, s50, 1
    s_cmp_gt_u32 s50, 400000
    s_cbranch_scc1 C_G1F2
    s_cbranch_vccnz R_G1F2
    s_branch C_G1F2
R_G1F3:
    s_nop 3
    buffer_load_dwordx4 v[112:115], v12, s[28:31], s68 offen offset:1536 sc1
    buffer_load_dwordx4 v[116:119], v12, s[28:31], s70 offen offset:1536 sc1
    buffer_load_dwordx4 v[120:123], v12, s[28:31], s68 offen offset:2048 sc1
    buffer_load_dwordx4 v[124:127], v12, s[28:31], s70 offen offset:2048 sc1
    buffer_load_dwordx4 v[88:91], v12, s[28:31], s68 offen offset:2560 sc1
    buffer_load_dwordx4 v[92:95], v12, s[28:31], s70 offen offset:2560 sc1
    buffer_load_dwordx4 v[96:99], v12, s[28:31], s68 offen offset:3072 sc1
    buffer_load_dwordx4 v[100:103], v12, s[28:31], s70 offen offset:3072 sc1
    s_waitcnt vmcnt(0)
    v_max_u32 v14, v119, v115
    v_cmp_eq_u32 vcc, -1, v14
    s_add_u32 s50, s50, 1
    s_cmp_gt_u32 s50, 400000
    s_cbranch_scc1 C_G1F3
    s_cbranch_vccnz R_G1F3
    s_branch C_G1F3
R_G1F4:
    s_nop 3
    buffer_load_dwordx4 v[120:123], v12, s[28:31], s68 offen offset:2048 sc1
    buffer_load_dwordx4 v[124:127], v12, s[28:31], s70 offen offset:2048 sc1
    buffer_load_dwordx4 v[88:91], v12, s[28:31], s68 offen offset:2560 sc1
    buffer_load_dwordx4 v[92:95], v12, s[28:31], s70 offen offset:2560 sc1
    buffer_load_dwordx4 v[96:99], v12, s[28:31], s68 offen offset:3072 sc1
    buffer_load_dwordx4 v[100:103], v12, s[28:31], s70 offen offset:3072 sc1
    buffer_load_dwordx4 v[104:107], v12, s[28:31], s68 offen offset:3584 sc1
    buffer_load_dwordx4 v[108:111], v12, s[28:31], s70 offen offset:3584 sc1
    s_waitcnt vmcnt(0)
    v_max_u32 v14, v127, v123
    v_cmp_eq_u32 vcc, -1, v14
    s_add_u32 s50, s50, 1
    s_cmp_gt_u32 s50, 400000
    s_cbranch_scc1 C_G1F4
    s_cbranch_vccnz R_G1F4
    s_branch C_G1F4
R_G1F5:
    s_nop 3
    buffer_load_dwordx4 v[88:91], v12, s[28:31], s68 offen offset:2560 sc1
    buffer_load_dwordx4 v[92:95], v12, s[28:31], s70 offen offset:2560 sc1
    buffer_load_dwordx4 v[96:99], v12, s[28:31], s68 offen offset:3072 sc1
    buffer_load_dwordx4 v[100:103], v12, s[28:31], s70 offen offset:3072 sc1
    buffer_load_dwordx4 v[104:107], v12, s[28:31], s68 offen offset:3584 sc1
    buffer_load_dwordx4 v[108:111], v12, s[28:31], s70 offen offset:3584 sc1
    buffer_load_dwordx4 v[112:115], v12, s[28:31], s69 offen offset:0 sc1
    buffer_load_dwordx4 v[116:119], v12, s[28:31], s71 offen offset:0 sc1
    s_waitcnt vmcnt(0)
    v_max_u32 v14, v95, v91
    v_cmp_eq_u32 vcc, -1, v14
    s_add_u32 s50, s50, 1
    s_cmp_gt_u32 s50, 400000
    s_cbranch_scc1 C_G1F5
    s_cbranch_vccnz R_G1F5
    s_branch C_G1F5
R_G1F6:
    s_nop 3
    buffer_load_dwordx4 v[96:99], v12, s[28:31], s68 offen offset:3072 sc1
    buffer_load_dwordx4 v[100:103], v12, s[28:31], s70 offen offset:3072 sc1
    buffer_load_dwordx4 v[104:107], v12, s[28:31], s68 offen offset:3584 sc1
    buffer_load_dwordx4 v[108:111], v12, s[28:31], s70 offen offset:3584 sc1
    buffer_load_dwordx4 v[112:115], v12, s[28:31], s69 offen offset:0 sc1
    buffer_load_dwordx4 v[116:119], v12, s[28:31], s71 offen offset:0 sc1
    buffer_load_dwordx4 v[120:123], v12, s[28:31], s69 offen offset:512 sc1
    buffer_load_dwordx4 v[124:127], v12, s[28:31], s71 offen offset:512 sc1
    s_waitcnt vmcnt(0)
    v_max_u32 v14, v103, v99
    v_cmp_eq_u32 vcc, -1, v14
    s_add_u32 s50, s50, 1
    s_cmp_gt_u32 s50, 400000
    s_cbranch_scc1 C_G1F6
    s_cbranch_vccnz R_G1F6
    s_branch C_G1F6
R_G1F7:
    s_nop 3
    buffer_load_dwordx4 v[104:107], v12, s[28:31], s68 offen offset:3584 sc1
    buffer_load_dwordx4 v[108:111], v12, s[28:31], s70 offen offset:3584 sc1
    buffer_load_dwordx4 v[112:115], v12, s[28:31], s69 offen offset:0 sc1
    buffer_load_dwordx4 v[116:119], v12, s[28:31], s71 offen offset:0 sc1
    buffer_load_dwordx4 v[120:123], v12, s[28:31], s69 offen offset:512 sc1
    buffer_load_dwordx4 v[124:127], v12, s[28:31], s71 offen offset:512 sc1
    buffer_load_dwordx4 v[88:91], v12, s[28:31], s69 offen offset:1024 sc1
    buffer_load_dwordx4 v[92:95], v12, s[28:31], s71 offen offset:1024 sc1
    s_waitcnt vmcnt(0)
    v_max_u32 v14, v111, v107
    v_cmp_eq_u32 vcc, -1, v14
    s_add_u32 s50, s50, 1
    s_cmp_gt_u32 s50, 400000
    s_cbranch_scc1 C_G1F7
    s_cbranch_vccnz R_G1F7
    s_branch C_G1F7
R_G1F8:
    s_nop 3
    buffer_load_dwordx4 v[112:115], v12, s[28:31], s69 offen offset:0 sc1
    buffer_load_dwordx4 v[116:119], v12, s[28:31], s71 offen offset:0 sc1
    buffer_load_dwordx4 v[120:123], v12, s[28:31], s69 offen offset:512 sc1
    buffer_load_dwordx4 v[124:127], v12, s[28:31], s71 offen offset:512 sc1
    buffer_load_dwordx4 v[88:91], v12, s[28:31], s69 offen offset:1024 sc1
    buffer_load_dwordx4 v[92:95], v12, s[28:31], s71 offen offset:1024 sc1
    buffer_load_dwordx4 v[96:99], v12, s[28:31], s69 offen offset:1536 sc1
    buffer_load_dwordx4 v[100:103], v12, s[28:31], s71 offen offset:1536 sc1
    s_waitcnt vmcnt(0)
    v_max_u32 v14, v119, v115
    v_cmp_eq_u32 vcc, -1, v14
    s_add_u32 s50, s50, 1
    s_cmp_gt_u32 s50, 400000
    s_cbranch_scc1 C_G1F8
    s_cbranch_vccnz R_G1F8
    s_branch C_G1F8
R_G1F9:
    s_nop 3
    buffer_load_dwordx4 v[120:123], v12, s[28:31], s69 offen offset:512 sc1
    buffer_load_dwordx4 v[124:127], v12, s[28:31], s71 offen offset:512 sc1
    buffer_load_dwordx4 v[88:91], v12, s[28:31], s69 offen offset:1024 sc1
    buffer_load_dwordx4 v[92:95], v12, s[28:31], s71 offen offset:1024 sc1
    buffer_load_dwordx4 v[96:99], v12, s[28:31], s69 offen offset:1536 sc1
    buffer_load_dwordx4 v[100:103], v12, s[28:31], s71 offen offset:1536 sc1
    buffer_load_dwordx4 v[104:107], v12, s[28:31], s69 offen offset:2048 sc1
    buffer_load_dwordx4 v[108:111], v12, s[28:31], s71 offen offset:2048 sc1
    s_waitcnt vmcnt(0)
    v_max_u32 v14, v127, v123
    v_cmp_eq_u32 vcc, -1, v14
    s_add_u32 s50, s50, 1
    s_cmp_gt_u32 s50, 400000
    s_cbranch_scc1 C_G1F9
    s_cbranch_vccnz R_G1F9
    s_branch C_G1F9
R_G1F10:
    s_nop 3
    buffer_load_dwordx4 v[88:91], v12, s[28:31], s69 offen offset:1024 sc1
    buffer_load_dwordx4 v[92:95], v12, s[28:31], s71 offen offset:1024 sc1
    buffer_load_dwordx4 v[96:99], v12, s[28:31], s69 offen offset:1536 sc1
    buffer_load_dwordx4 v[100:103], v12, s[28:31], s71 offen offset:1536 sc1
    buffer_load_dwordx4 v[104:107], v12, s[28:31], s69 offen offset:2048 sc1
    buffer_load_dwordx4 v[108:111], v12, s[28:31], s71 offen offset:2048 sc1
    buffer_load_dwordx4 v[112:115], v12, s[28:31], s69 offen offset:2560 sc1
    buffer_load_dwordx4 v[116:119], v12, s[28:31], s71 offen offset:2560 sc1
    s_waitcnt vmcnt(0)
    v_max_u32 v14, v95, v91
    v_cmp_eq_u32 vcc, -1, v14
    s_add_u32 s50, s50, 1
    s_cmp_gt_u32 s50, 400000
    s_cbranch_scc1 C_G1F10
    s_cbranch_vccnz R_G1F10
    s_branch C_G1F10
R_G1F11:
    s_nop 3
    buffer_load_dwordx4 v[96:99], v12, s[28:31], s69 offen offset:1536 sc1
    buffer_load_dwordx4 v[100:103], v12, s[28:31], s71 offen offset:1536 sc1
    buffer_load_dwordx4 v[104:107], v12, s[28:31], s69 offen offset:2048 sc1
    buffer_load_dwordx4 v[108:111], v12, s[28:31], s71 offen offset:2048 sc1
    buffer_load_dwordx4 v[112:115], v12, s[28:31], s69 offen offset:2560 sc1
    buffer_load_dwordx4 v[116:119], v12, s[28:31], s71 offen offset:2560 sc1
    buffer_load_dwordx4 v[120:123], v12, s[28:31], s69 offen offset:3072 sc1
    buffer_load_dwordx4 v[124:127], v12, s[28:31], s71 offen offset:3072 sc1
    s_waitcnt vmcnt(0)
    v_max_u32 v14, v103, v99
    v_cmp_eq_u32 vcc, -1, v14
    s_add_u32 s50, s50, 1
    s_cmp_gt_u32 s50, 400000
    s_cbranch_scc1 C_G1F11
    s_cbranch_vccnz R_G1F11
    s_branch C_G1F11
R_G1F12:
    s_nop 3
    buffer_load_dwordx4 v[104:107], v12, s[28:31], s69 offen offset:2048 sc1
    buffer_load_dwordx4 v[108:111], v12, s[28:31], s71 offen offset:2048 sc1
    buffer_load_dwordx4 v[112:115], v12, s[28:31], s69 offen offset:2560 sc1
    buffer_load_dwordx4 v[116:119], v12, s[28:31], s71 offen offset:2560 sc1
    buffer_load_dwordx4 v[120:123], v12, s[28:31], s69 offen offset:3072 sc1
    buffer_load_dwordx4 v[124:127], v12, s[28:31], s71 offen offset:3072 sc1
    buffer_load_dwordx4 v[88:91], v12, s[28:31], s69 offen offset:3584 sc1
    buffer_load_dwordx4 v[92:95], v12, s[28:31], s71 offen offset:3584 sc1
    s_waitcnt vmcnt(0)
    v_max_u32 v14, v111, v107
    v_cmp_eq_u32 vcc, -1, v14
    s_add_u32 s50, s50, 1
    s_cmp_gt_u32 s50, 400000
    s_cbranch_scc1 C_G1F12
    s_cbranch_vccnz R_G1F12
    s_branch C_G1F12
R_G1F13:
    s_nop 3
    buffer_load_dwordx4 v[112:115], v12, s[28:31], s69 offen offset:2560 sc1
    buffer_load_dwordx4 v[116:119], v12, s[28:31], s71 offen offset:2560 sc1
    buffer_load_dwordx4 v[120:123], v12, s[28:31], s69 offen offset:3072 sc1
    buffer_load_dwordx4 v[124:127], v12, s[28:31], s71 offen offset:3072 sc1
    buffer_load_dwordx4 v[88:91], v12, s[28:31], s69 offen offset:3584 sc1
    buffer_load_dwordx4 v[92:95], v12, s[28:31], s71 offen offset:3584 sc1
    s_waitcnt vmcnt(0)
    v_max_u32 v14, v119, v115
    v_cmp_eq_u32 vcc, -1, v14
    s_add_u32 s50, s50, 1
    s_cmp_gt_u32 s50, 400000
    s_cbranch_scc1 C_G1F13
    s_cbranch_vccnz R_G1F13
    s_branch C_G1F13
R_G1F14:
    s_nop 3
    buffer_load_dwordx4 v[120:123], v12, s[28:31], s69 offen offset:3072 sc1
    buffer_load_dwordx4 v[124:127], v12, s[28:31], s71 offen offset:3072 sc1
    buffer_load_dwordx4 v[88:91], v12, s[28:31], s69 offen offset:3584 sc1
    buffer_load_dwordx4 v[92:95], v12, s[28:31], s71 offen offset:3584 sc1
    s_waitcnt vmcnt(0)
    v_max_u32 v14, v127, v123
    v_cmp_eq_u32 vcc, -1, v14
    s_add_u32 s50, s50, 1
    s_cmp_gt_u32 s50, 400000
    s_cbranch_scc1 C_G1F14
    s_cbranch_vccnz R_G1F14
    s_branch C_G1F14
R_G1F15:
    s_nop 3
    buffer_load_dwordx4 v[88:91], v12, s[28:31], s69 offen offset:3584 sc1
    buffer_load_dwordx4 v[92:95], v12, s[28:31], s71 offen offset:3584 sc1
    s_waitcnt vmcnt(0)
    v_max_u32 v14, v95, v91
    v_cmp_eq_u32 vcc, -1, v14
    s_add_u32 s50, s50, 1
    s_cmp_gt_u32 s50, 400000
    s_cbranch_scc1 C_G1F15
    s_cbranch_vccnz R_G1F15
    s_branch C_G1F15
R_H:
    s_nop 3
    buffer_load_dwordx4 v[88:91], v22, s[28:31], s78 offen sc1
    buffer_load_dwordx4 v[92:95], v22, s[28:31], s79 offen sc1
    s_waitcnt vmcnt(0)
    v_xor_b32 v14, s57, v88
    v_bitop3_b32 v14, v14, v91, s57 bitop3:0xf6
    v_bitop3_b32 v14, v14, v92, s57 bitop3:0xf6
    v_bitop3_b32 v14, v14, v95, s57 bitop3:0xf6
    v_and_b32 v14, v3, v14
    v_cmp_ne_u32 vcc, 0, v14
    s_add_u32 s50, s50, 1
    s_cmp_gt_u32 s50, 400000
    s_cbranch_scc1 C_H
    s_cbranch_vccnz R_H
    s_branch C_H
R_XP:
    s_nop 3
    buffer_load_dwordx4 v[96:99], v2, s[28:31], s85 offen offset:0 sc1
    buffer_load_dwordx4 v[100:103], v2, s[28:31], s85 offen offset:1024 sc1
    s_waitcnt vmcnt(0)
    v_xor_b32 v14, s57, v103
    v_bitop3_b32 v14, v14, v100, s57 bitop3:0xf6
    v_bitop3_b32 v14, v14, v99, s57 bitop3:0xf6
    v_bitop3_b32 v14, v14, v96, s57 bitop3:0xf6
    v_and_b32 v14, v3, v14
    v_cmp_ne_u32 vcc, 0, v14
    s_add_u32 s50, s50, 1
    s_cmp_gt_u32 s50, 400000
    s_cbranch_scc1 C_XP
    s_cbranch_vccnz R_XP
    s_branch C_XP
R_G1L0:
    s_nop 3
    buffer_load_dwordx4 v[72:75], v12, s[28:31], s70 offen offset:0 sc1
    buffer_load_dwordx4 v[76:79], v12, s[28:31], s72 offen offset:0 sc1
    buffer_load_dwordx4 v[80:83], v12, s[28:31], s70 offen offset:512 sc1
    buffer_load_dwordx4 v[84:87], v12, s[28:31], s72 offen offset:512 sc1
    buffer_load_dwordx4 v[88:91], v12, s[28:31], s70 offen offset:1024 sc1
    buffer_load_dwordx4 v[92:95], v12, s[28:31], s72 offen offset:1024 sc1
    buffer_load_dwordx4 v[96:99], v12, s[28:31], s70 offen offset:1536 sc1
    buffer_load_dwordx4 v[100:103], v12, s[28:31], s72 offen offset:1536 sc1
    buffer_load_dwordx4 v[104:107], v12, s[28:31], s70 offen offset:2048 sc1
    buffer_load_dwordx4 v[108:111], v12, s[28:31], s72 offen offset:2048 sc1
    buffer_load_dwordx4 v[112:115], v12, s[28:31], s70 offen offset:2560 sc1
    buffer_load_dwordx4 v[116:119], v12, s[28:31], s72 offen offset:2560 sc1
    buffer_load_dwordx4 v[120:123], v12, s[28:31], s70 offen offset:3072 sc1
    buffer_load_dwordx4 v[124:127], v12, s[28:31], s72 offen offset:3072 sc1
    s_waitcnt vmcnt(0)
    v_max_u32 v14, v79, v75
    v_cmp_eq_u32 vcc, -1, v14
    s_add_u32 s50, s50, 1
    s_cmp_gt_u32 s50, 400000
    s_cbranch_scc1 C_G1L0
    s_cbranch_vccnz R_G1L0
    s_branch C_G1L0
R_G1L1:
    s_nop 3
    buffer_load_dwordx4 v[80:83], v12, s[28:31], s70 offen offset:512 sc1
    buffer_load_dwordx4 v[84:87], v12, s[28:31], s72 offen offset:512 sc1
    buffer_load_dwordx4 v[88:91], v12, s[28:31], s70 offen offset:1024 sc1
    buffer_load_dwordx4 v[92:95], v12, s[28:31], s72 offen offset:1024 sc1
    buffer_load_dwordx4 v[96:99], v12, s[28:31], s70 offen offset:1536 sc1
    buffer_load_dwordx4 v[100:103], v12, s[28:31], s72 offen offset:1536 sc1
    buffer_load_dwordx4 v[104:107], v12, s[28:31], s70 offen offset:2048 sc1
    buffer_load_dwordx4 v[108:111], v12, s[28:31], s72 offen offset:2048 sc1
    buffer_load_dwordx4 v[112:115], v12, s[28:31], s70 offen offset:2560 sc1
    buffer_load_dwordx4 v[116:119], v12, s[28:31], s72 offen offset:2560 sc1
    buffer_load_dwordx4 v[120:123], v12, s[28:31], s70 offen offset:3072 sc1
    buffer_load_dwordx4 v[124:127], v12, s[28:31], s72 offen offset:3072 sc1
    s_waitcnt vmcnt(0)
    v_max_u32 v14, v87, v83
    v_cmp_eq_u32 vcc, -1, v14
    s_add_u32 s50, s50, 1
    s_cmp_gt_u32 s50, 400000
    s_cbranch_scc1 C_G1L1
    s_cbranch_vccnz R_G1L1
    s_branch C_G1L1
R_G1L2:
    s_nop 3
    buffer_load_dwordx4 v[88:91], v12, s[28:31], s70 offen offset:1024 sc1
    buffer_load_dwordx4 v[92:95], v12, s[28:31], s72 offen offset:1024 sc1
    buffer_load_dwordx4 v[96:99], v12, s[28:31], s70 offen offset:1536 sc1
    buffer_load_dwordx4 v[100:103], v12, s[28:31], s72 offen offset:1536 sc1
    buffer_load_dwordx4 v[104:107], v12, s[28:31], s70 offen offset:2048 sc1
    buffer_load_dwordx4 v[108:111], v12, s[28:31], s72 offen offset:2048 sc1
    buffer_load_dwordx4 v[112:115], v12, s[28:31], s70 offen offset:2560 sc1
    buffer_load_dwordx4 v[116:119], v12, s[28:31], s72 offen offset:2560 sc1
    buffer_load_dwordx4 v[120:123], v12, s[28:31], s70 offen offset:3072 sc1
    buffer_load_dwordx4 v[124:127], v12, s[28:31], s72 offen offset:3072 sc1
    buffer_load_dwordx4 v[72:75], v12, s[28:31], s70 offen offset:3584 sc1
    buffer_load_dwordx4 v[76:79], v12, s[28:31], s72 offen offset:3584 sc1
    s_waitcnt vmcnt(0)
    v_max_u32 v14, v95, v91
    v_cmp_eq_u32 vcc, -1, v14
    s_add_u32 s50, s50, 1
    s_cmp_gt_u32 s50, 400000
    s_cbranch_scc1 C_G1L2
    s_cbranch_vccnz R_G1L2
    s_branch C_G1L2
R_G1L3:
    s_nop 3
    buffer_load_dwordx4 v[96:99], v12, s[28:31], s70 offen offset:1536 sc1
    buffer_load_dwordx4 v[100:103], v12, s[28:31], s72 offen offset:1536 sc1
    buffer_load_dwordx4 v[104:107], v12, s[28:31], s70 offen offset:2048 sc1
    buffer_load_dwordx4 v[108:111], v12, s[28:31], s72 offen offset:2048 sc1
    buffer_load_dwordx4 v[112:115], v12, s[28:31], s70 offen offset:2560 sc1
    buffer_load_dwordx4 v[116:119], v12, s[28:31], s72 offen offset:2560 sc1
    buffer_load_dwordx4 v[120:123], v12, s[28:31], s70 offen offset:3072 sc1
    buffer_load_dwordx4 v[124:127], v12, s[28:31], s72 offen offset:3072 sc1
    buffer_load_dwordx4 v[72:75], v12, s[28:31], s70 offen offset:3584 sc1
    buffer_load_dwordx4 v[76:79], v12, s[28:31], s72 offen offset:3584 sc1
    buffer_load_dwordx4 v[80:83], v12, s[28:31], s71 offen offset:0 sc1
    buffer_load_dwordx4 v[84:87], v12, s[28:31], s73 offen offset:0 sc1
    s_waitcnt vmcnt(0)
    v_max_u32 v14, v103, v99
    v_cmp_eq_u32 vcc, -1, v14
    s_add_u32 s50, s50, 1
    s_cmp_gt_u32 s50, 400000
    s_cbranch_scc1 C_G1L3
    s_cbranch_vccnz R_G1L3
    s_branch C_G1L3
R_G1L4:
    s_nop 3
    buffer_load_dwordx4 v[104:107], v12, s[28:31], s70 offen offset:2048 sc1
    buffer_load_dwordx4 v[108:111], v12, s[28:31], s72 offen offset:2048 sc1
    buffer_load_dwordx4 v[112:115], v12, s[28:31], s70 offen offset:2560 sc1
    buffer_load_dwordx4 v[116:119], v12, s[28:31], s72 offen offset:2560 sc1
    buffer_load_dwordx4 v[120:123], v12, s[28:31], s70 offen offset:3072 sc1
    buffer_load_dwordx4 v[124:127], v12, s[28:31], s72 offen offset:3072 sc1
    buffer_load_dwordx4 v[72:75], v12, s[28:31], s70 offen offset:3584 sc1
    buffer_load_dwordx4 v[76:79], v12, s[28:31], s72 offen offset:3584 sc1
    buffer_load_dwordx4 v[80:83], v12, s[28:31], s71 offen offset:0 sc1
    buffer_load_dwordx4 v[84:87], v12, s[28:31], s73 offen offset:0 sc1
    buffer_load_dwordx4 v[88:91], v12, s[28:31], s71 offen offset:512 sc1
    buffer_load_dwordx4 v[92:95], v12, s[28:31], s73 offen offset:512 sc1
    s_waitcnt vmcnt(0)
    v_max_u32 v14, v111, v107
    v_cmp_eq_u32 vcc, -1, v14
    s_add_u32 s50, s50, 1
    s_cmp_gt_u32 s50, 400000
    s_cbranch_scc1 C_G1L4
    s_cbranch_vccnz R_G1L4
    s_branch C_G1L4
R_G1L5:
    s_nop 3
    buffer_load_dwordx4 v[112:115], v12, s[28:31], s70 offen offset:2560 sc1
    buffer_load_dwordx4 v[116:119], v12, s[28:31], s72 offen offset:2560 sc1
    buffer_load_dwordx4 v[120:123], v12, s[28:31], s70 offen offset:3072 sc1
    buffer_load_dwordx4 v[124:127], v12, s[28:31], s72 offen offset:3072 sc1
    buffer_load_dwordx4 v[72:75], v12, s[28:31], s70 offen offset:3584 sc1
    buffer_load_dwordx4 v[76:79], v12, s[28:31], s72 offen offset:3584 sc1
    buffer_load_dwordx4 v[80:83], v12, s[28:31], s71 offen offset:0 sc1
    buffer_load_dwordx4 v[84:87], v12, s[28:31], s73 offen offset:0 sc1
    buffer_load_dwordx4 v[88:91], v12, s[28:31], s71 offen offset:512 sc1
    buffer_load_dwordx4 v[92:95], v12, s[28:31], s73 offen offset:512 sc1
    buffer_load_dwordx4 v[96:99], v12, s[28:31], s71 offen offset:1024 sc1
    buffer_load_dwordx4 v[100:103], v12, s[28:31], s73 offen offset:1024 sc1
    s_waitcnt vmcnt(0)
    v_max_u32 v14, v119, v115
    v_cmp_eq_u32 vcc, -1, v14
    s_add_u32 s50, s50, 1
    s_cmp_gt_u32 s50, 400000
    s_cbranch_scc1 C_G1L5
    s_cbranch_vccnz R_G1L5
    s_branch C_G1L5
R_G1L6:
    s_nop 3
    buffer_load_dwordx4 v[120:123], v12, s[28:31], s70 offen offset:3072 sc1
    buffer_load_dwordx4 v[124:127], v12, s[28:31], s72 offen offset:3072 sc1
    buffer_load_dwordx4 v[72:75], v12, s[28:31], s70 offen offset:3584 sc1
    buffer_load_dwordx4 v[76:79], v12, s[28:31], s72 offen offset:3584 sc1
    buffer_load_dwordx4 v[80:83], v12, s[28:31], s71 offen offset:0 sc1
    buffer_load_dwordx4 v[84:87], v12, s[28:31], s73 offen offset:0 sc1
    buffer_load_dwordx4 v[88:91], v12, s[28:31], s71 offen offset:512 sc1
    buffer_load_dwordx4 v[92:95], v12, s[28:31], s73 offen offset:512 sc1
    buffer_load_dwordx4 v[96:99], v12, s[28:31], s71 offen offset:1024 sc1
    buffer_load_dwordx4 v[100:103], v12, s[28:31], s73 offen offset:1024 sc1
    buffer_load_dwordx4 v[104:107], v12, s[28:31], s71 offen offset:1536 sc1
    buffer_load_dwordx4 v[108:111], v12, s[28:31], s73 offen offset:1536 sc1
    s_waitcnt vmcnt(0)
    v_max_u32 v14, v127, v123
    v_cmp_eq_u32 vcc, -1, v14
    s_add_u32 s50, s50, 1
    s_cmp_gt_u32 s50, 400000
    s_cbranch_scc1 C_G1L6
    s_cbranch_vccnz R_G1L6
    s_branch C_G1L6
R_G1L7:
    s_nop 3
    buffer_load_dwordx4 v[72:75], v12, s[28:31], s70 offen offset:3584 sc1
    buffer_load_dwordx4 v[76:79], v12, s[28:31], s72 offen offset:3584 sc1
    buffer_load_dwordx4 v[80:83], v12, s[28:31], s71 offen offset:0 sc1
    buffer_load_dwordx4 v[84:87], v12, s[28:31], s73 offen offset:0 sc1
    buffer_load_dwordx4 v[88:91], v12, s[28:31], s71 offen offset:512 sc1
    buffer_load_dwordx4 v[92:95], v12, s[28:31], s73 offen offset:512 sc1
    buffer_load_dwordx4 v[96:99], v12, s[28:31], s71 offen offset:1024 sc1
    buffer_load_dwordx4 v[100:103], v12, s[28:31], s73 offen offset:1024 sc1
    buffer_load_dwordx4 v[104:107], v12, s[28:31], s71 offen offset:1536 sc1
    buffer_load_dwordx4 v[108:111], v12, s[28:31], s73 offen offset:1536 sc1
    buffer_load_dwordx4 v[112:115], v12, s[28:31], s71 offen offset:2048 sc1
    buffer_load_dwordx4 v[116:119], v12, s[28:31], s73 offen offset:2048 sc1
    s_waitcnt vmcnt(0)
    v_max_u32 v14, v79, v75
    v_cmp_eq_u32 vcc, -1, v14
    s_add_u32 s50, s50, 1
    s_cmp_gt_u32 s50, 400000
    s_cbranch_scc1 C_G1L7
    s_cbranch_vccnz R_G1L7
    s_branch C_G1L7
R_G1L8:
    s_nop 3
    buffer_load_dwordx4 v[80:83], v12, s[28:31], s71 offen offset:0 sc1
    buffer_load_dwordx4 v[84:87], v12, s[28:31], s73 offen offset:0 sc1
    buffer_load_dwordx4 v[88:91], v12, s[28:31], s71 offen offset:512 sc1
    buffer_load_dwordx4 v[92:95], v12, s[28:31], s73 offen offset:512 sc1
    buffer_load_dwordx4 v[96:99], v12, s[28:31], s71 offen offset:1024 sc1
    buffer_load_dwordx4 v[100:103], v12, s[28:31], s73 offen offset:1024 sc1
    buffer_load_dwordx4 v[104:107], v12, s[28:31], s71 offen offset:1536 sc1
    buffer_load_dwordx4 v[108:111], v12, s[28:31], s73 offen offset:1536 sc1
    buffer_load_dwordx4 v[112:115], v12, s[28:31], s71 offen offset:2048 sc1
    buffer_load_dwordx4 v[116:119], v12, s[28:31], s73 offen offset:2048 sc1
    buffer_load_dwordx4 v[120:123], v12, s[28:31], s71 offen offset:2560 sc1
    buffer_load_dwordx4 v[124:127], v12, s[28:31], s73 offen offset:2560 sc1
    s_waitcnt vmcnt(0)
    v_max_u32 v14, v87, v83
    v_cmp_eq_u32 vcc, -1, v14
    s_add_u32 s50, s50, 1
    s_cmp_gt_u32 s50, 400000
    s_cbranch_scc1 C_G1L8
    s_cbranch_vccnz R_G1L8
    s_branch C_G1L8
R_G1L9:
    s_nop 3
    buffer_load_dwordx4 v[88:91], v12, s[28:31], s71 offen offset:512 sc1
    buffer_load_dwordx4 v[92:95], v12, s[28:31], s73 offen offset:512 sc1
    buffer_load_dwordx4 v[96:99], v12, s[28:31], s71 offen offset:1024 sc1
    buffer_load_dwordx4 v[100:103], v12, s[28:31], s73 offen offset:1024 sc1
    buffer_load_dwordx4 v[104:107], v12, s[28:31], s71 offen offset:1536 sc1
    buffer_load_dwordx4 v[108:111], v12, s[28:31], s73 offen offset:1536 sc1
    buffer_load_dwordx4 v[112:115], v12, s[28:31], s71 offen offset:2048 sc1
    buffer_load_dwordx4 v[116:119], v12, s[28:31], s73 offen offset:2048 sc1
    buffer_load_dwordx4 v[120:123], v12, s[28:31], s71 offen offset:2560 sc1
    buffer_load_dwordx4 v[124:127], v12, s[28:31], s73 offen offset:2560 sc1
    buffer_load_dwordx4 v[72:75], v12, s[28:31], s71 offen offset:3072 sc1
    buffer_load_dwordx4 v[76:79], v12, s[28:31], s73 offen offset:3072 sc1
    s_waitcnt vmcnt(0)
    v_max_u32 v14, v95, v91
    v_cmp_eq_u32 vcc, -1, v14
    s_add_u32 s50, s50, 1
    s_cmp_gt_u32 s50, 400000
    s_cbranch_scc1 C_G1L9
    s_cbranch_vccnz R_G1L9
    s_branch C_G1L9
R_G1L10:
    s_nop 3
    buffer_load_dwordx4 v[96:99], v12, s[28:31], s71 offen offset:1024 sc1
    buffer_load_dwordx4 v[100:103], v12, s[28:31], s73 offen offset:1024 sc1
    buffer_load_dwordx4 v[104:107], v12, s[28:31], s71 offen offset:1536 sc1
    buffer_load_dwordx4 v[108:111], v12, s[28:31], s73 offen offset:1536 sc1
    buffer_load_dwordx4 v[112:115], v12, s[28:31], s71 offen offset:2048 sc1
    buffer_load_dwordx4 v[116:119], v12, s[28:31], s73 offen offset:2048 sc1
    buffer_load_dwordx4 v[120:123], v12, s[28:31], s71 offen offset:2560 sc1
    buffer_load_dwordx4 v[124:127], v12, s[28:31], s73 offen offset:2560 sc1
    buffer_load_dwordx4 v[72:75], v12, s[28:31], s71 offen offset:3072 sc1
    buffer_load_dwordx4 v[76:79], v12, s[28:31], s73 offen offset:3072 sc1
    buffer_load_dwordx4 v[80:83], v12, s[28:31], s71 offen offset:3584 sc1
    buffer_load_dwordx4 v[84:87], v12, s[28:31], s73 offen offset:3584 sc1
    s_waitcnt vmcnt(0)
    v_max_u32 v14, v103, v99
    v_cmp_eq_u32 vcc, -1, v14
    s_add_u32 s50, s50, 1
    s_cmp_gt_u32 s50, 400000
    s_cbranch_scc1 C_G1L10
    s_cbranch_vccnz R_G1L10
    s_branch C_G1L10
R_G1L11:
    s_nop 3
    buffer_load_dwordx4 v[104:107], v12, s[28:31], s71 offen offset:1536 sc1
    buffer_load_dwordx4 v[108:111], v12, s[28:31], s73 offen offset:1536 sc1
    buffer_load_dwordx4 v[112:115], v12, s[28:31], s71 offen offset:2048 sc1
    buffer_load_dwordx4 v[116:119], v12, s[28:31], s73 offen offset:2048 sc1
    buffer_load_dwordx4 v[120:123], v12, s[28:31], s71 offen offset:2560 sc1
    buffer_load_dwordx4 v[124:127], v12, s[28:31], s73 offen offset:2560 sc1
    buffer_load_dwordx4 v[72:75], v12, s[28:31], s71 offen offset:3072 sc1
    buffer_load_dwordx4 v[76:79], v12, s[28:31], s73 offen offset:3072 sc1
    buffer_load_dwordx4 v[80:83], v12, s[28:31], s71 offen offset:3584 sc1
    buffer_load_dwordx4 v[84:87], v12, s[28:31], s73 offen offset:3584 sc1
    s_waitcnt vmcnt(0)
    v_max_u32 v14, v111, v107
    v_cmp_eq_u32 vcc, -1, v14
    s_add_u32 s50, s50, 1
    s_cmp_gt_u32 s50, 400000
    s_cbranch_scc1 C_G1L11
    s_cbranch_vccnz R_G1L11
    s_branch C_G1L11
R_G1L12:
    s_nop 3
    buffer_load_dwordx4 v[112:115], v12, s[28:31], s71 offen offset:2048 sc1
    buffer_load_dwordx4 v[116:119], v12, s[28:31], s73 offen offset:2048 sc1
    buffer_load_dwordx4 v[120:123], v12, s[28:31], s71 offen offset:2560 sc1
    buffer_load_dwordx4 v[124:127], v12, s[28:31], s73 offen offset:2560 sc1
    buffer_load_dwordx4 v[72:75], v12, s[28:31], s71 offen offset:3072 sc1
    buffer_load_dwordx4 v[76:79], v12, s[28:31], s73 offen offset:3072 sc1
    buffer_load_dwordx4 v[80:83], v12, s[28:31], s71 offen offset:3584 sc1
    buffer_load_dwordx4 v[84:87], v12, s[28:31], s73 offen offset:3584 sc1
    s_waitcnt vmcnt(0)
    v_max_u32 v14, v119, v115
    v_cmp_eq_u32 vcc, -1, v14
    s_add_u32 s50, s50, 1
    s_cmp_gt_u32 s50, 400000
    s_cbranch_scc1 C_G1L12
    s_cbranch_vccnz R_G1L12
    s_branch C_G1L12
R_G1L13:
    s_nop 3
    buffer_load_dwordx4 v[120:123], v12, s[28:31], s71 offen offset:2560 sc1
    buffer_load_dwordx4 v[124:127], v12, s[28:31], s73 offen offset:2560 sc1
    buffer_load_dwordx4 v[72:75], v12, s[28:31], s71 offen offset:3072 sc1
    buffer_load_dwordx4 v[76:79], v12, s[28:31], s73 offen offset:3072 sc1
    buffer_load_dwordx4 v[80:83], v12, s[28:31], s71 offen offset:3584 sc1
    buffer_load_dwordx4 v[84:87], v12, s[28:31], s73 offen offset:3584 sc1
    s_waitcnt vmcnt(0)
    v_max_u32 v14, v127, v123
    v_cmp_eq_u32 vcc, -1, v14
    s_add_u32 s50, s50, 1
    s_cmp_gt_u32 s50, 400000
    s_cbranch_scc1 C_G1L13
    s_cbranch_vccnz R_G1L13
    s_branch C_G1L13
R_G1L14:
    s_nop 3
    buffer_load_dwordx4 v[72:75], v12, s[28:31], s71 offen offset:3072 sc1
    buffer_load_dwordx4 v[76:79], v12, s[28:31], s73 offen offset:3072 sc1
    buffer_load_dwordx4 v[80:83], v12, s[28:31], s71 offen offset:3584 sc1
    buffer_load_dwordx4 v[84:87], v12, s[28:31], s73 offen offset:3584 sc1
    s_waitcnt vmcnt(0)
    v_max_u32 v14, v79, v75
    v_cmp_eq_u32 vcc, -1, v14
    s_add_u32 s50, s50, 1
    s_cmp_gt_u32 s50, 400000
    s_cbranch_scc1 C_G1L14
    s_cbranch_vccnz R_G1L14
    s_branch C_G1L14
R_G1L15:
    s_nop 3
    buffer_load_dwordx4 v[80:83], v12, s[28:31], s71 offen offset:3584 sc1
    buffer_load_dwordx4 v[84:87], v12, s[28:31], s73 offen offset:3584 sc1
    s_waitcnt vmcnt(0)
    v_max_u32 v14, v87, v83
    v_cmp_eq_u32 vcc, -1, v14
    s_add_u32 s50, s50, 1
    s_cmp_gt_u32 s50, 400000
    s_cbranch_scc1 C_G1L15
    s_cbranch_vccnz R_G1L15
    s_branch C_G1L15
R_G2_0:
    s_nop 3
    buffer_load_dwordx4 v[4:7], v13, s[28:31], s78 offen offset:0 sc1
    buffer_load_dwordx4 v[8:11], v13, s[28:31], s78 offen offset:256 sc1
    buffer_load_dwordx4 v[88:91], v13, s[28:31], s79 offen offset:0 sc1
    buffer_load_dwordx4 v[92:95], v13, s[28:31], s79 offen offset:256 sc1
    s_waitcnt vmcnt(0)
    v_xor_b32 v14, s57, v95
    v_bitop3_b32 v14, v14, v91, s57 bitop3:0xf6
    v_bitop3_b32 v14, v14, v11, s57 bitop3:0xf6
    v_bitop3_b32 v14, v14, v7, s57 bitop3:0xf6
    v_and_b32 v14, v3, v14
    v_cmp_ne_u32 vcc, 0, v14
    s_add_u32 s50, s50, 1
    s_cmp_gt_u32 s50, 400000
    s_cbranch_scc1 C_G2_0
    s_cbranch_vccnz R_G2_0
    s_branch C_G2_0
R_G2_2:
    s_nop 3
    buffer_load_dwordx4 v[96:99], v13, s[28:31], s78 offen offset:1024 sc1
    buffer_load_dwordx4 v[100:103], v13, s[28:31], s78 offen offset:1280 sc1
    buffer_load_dwordx4 v[104:107], v13, s[28:31], s79 offen offset:1024 sc1
    buffer_load_dwordx4 v[108:111], v13, s[28:31], s79 offen offset:1280 sc1
    s_waitcnt vmcnt(0)
    v_xor_b32 v14, s57, v111
    v_bitop3_b32 v14, v14, v107, s57 bitop3:0xf6
    v_bitop3_b32 v14, v14, v103, s57 bitop3:0xf6
    v_bitop3_b32 v14, v14, v99, s57 bitop3:0xf6
    v_and_b32 v14, v3, v14
    v_cmp_ne_u32 vcc, 0, v14
    s_add_u32 s50, s50, 1
    s_cmp_gt_u32 s50, 400000
    s_cbranch_scc1 C_G2_2
    s_cbranch_vccnz R_G2_2
    s_branch C_G2_2
R_G2_4:
    s_nop 3
    buffer_load_dwordx4 v[112:115], v13, s[28:31], s81 offen offset:0 sc1
    buffer_load_dwordx4 v[116:119], v13, s[28:31], s81 offen offset:256 sc1
    buffer_load_dwordx4 v[120:123], v13, s[28:31], s82 offen offset:0 sc1
    buffer_load_dwordx4 v[124:127], v13, s[28:31], s82 offen offset:256 sc1
    s_waitcnt vmcnt(0)
    v_xor_b32 v14, s57, v127
    v_bitop3_b32 v14, v14, v123, s57 bitop3:0xf6
    v_bitop3_b32 v14, v14, v119, s57 bitop3:0xf6
    v_bitop3_b32 v14, v14, v115, s57 bitop3:0xf6
    v_and_b32 v14, v3, v14
    v_cmp_ne_u32 vcc, 0, v14
    s_add_u32 s50, s50, 1
    s_cmp_gt_u32 s50, 400000
    s_cbranch_scc1 C_G2_4
    s_cbranch_vccnz R_G2_4
    s_branch C_G2_4
YG117r:
    ds_read_b32 v17, v22
    s_add_u32 s51, s51, 1
    s_cmp_lt_u32 s51, 3200000
    s_waitcnt lgkmcnt(0)
    s_cbranch_scc0 YG117c
    v_cmp_gt_u32 vcc, 117, v17
    s_nop 0
    s_cbranch_vccnz YG117r
    s_branch YG117c
R_G2_6:
    s_nop 3
    buffer_load_dwordx4 a[112:115], v13, s[28:31], s78 offen offset:2048 sc1
    buffer_load_dwordx4 a[116:119], v13, s[28:31], s78 offen offset:2304 sc1
    buffer_load_dwordx4 a[120:123], v13, s[28:31], s79 offen offset:2048 sc1
    buffer_load_dwordx4 a[124:127], v13, s[28:31], s79 offen offset:2304 sc1
    buffer_load_dwordx4 v[4:7], v13, s[28:31], s80 offen offset:3072 sc1
    buffer_load_dwordx4 v[8:11], v13, s[28:31], s80 offen offset:3328 sc1
    s_waitcnt vmcnt(0)
    v_xor_b32 v14, s57, v11
    v_bitop3_b32 v14, v14, v7, s57 bitop3:0xf6
    v_accvgpr_read_b32 v15, a127
    v_bitop3_b32 v14, v14, v15, s57 bitop3:0xf6
    v_accvgpr_read_b32 v15, a123
    v_bitop3_b32 v14, v14, v15, s57 bitop3:0xf6
    v_accvgpr_read_b32 v15, a119
    v_bitop3_b32 v14, v14, v15, s57 bitop3:0xf6
    v_accvgpr_read_b32 v15, a115
    v_bitop3_b32 v14, v14, v15, s57 bitop3:0xf6
    v_and_b32 v14, v3, v14
    v_cmp_ne_u32 vcc, 0, v14
    s_add_u32 s50, s50, 1
    s_cmp_gt_u32 s50, 400000
    s_cbranch_scc1 C_G2_6
    s_cbranch_vccnz R_G2_6
    s_branch C_G2_6
R_G2_9:
    s_nop 3
    buffer_load_dwordx4 v[88:91], v13, s[28:31], s81 offen offset:1024 sc1
    buffer_load_dwordx4 v[92:95], v13, s[28:31], s81 offen offset:1280 sc1
    buffer_load_dwordx4 v[96:99], v13, s[28:31], s82 offen offset:1024 sc1
    buffer_load_dwordx4 v[100:103], v13, s[28:31], s82 offen offset:1280 sc1
    s_waitcnt vmcnt(0)
    v_xor_b32 v14, s57, v103
    v_bitop3_b32 v14, v14, v99, s57 bitop3:0xf6
    v_bitop3_b32 v14, v14, v95, s57 bitop3:0xf6
    v_bitop3_b32 v14, v14, v91, s57 bitop3:0xf6
    v_and_b32 v14, v3, v14
    v_cmp_ne_u32 vcc, 0, v14
    s_add_u32 s50, s50, 1
    s_cmp_gt_u32 s50, 400000
    s_cbranch_scc1 C_G2_9
    s_cbranch_vccnz R_G2_9
    s_branch C_G2_9
R_G2_11:
    s_nop 3
    buffer_load_dwordx4 v[104:107], v13, s[28:31], s81 offen offset:2048 sc1
    buffer_load_dwordx4 v[108:111], v13, s[28:31], s81 offen offset:2304 sc1
    buffer_load_dwordx4 v[112:115], v13, s[28:31], s82 offen offset:2048 sc1
    buffer_load_dwordx4 v[116:119], v13, s[28:31], s82 offen offset:2304 sc1
    buffer_load_dwordx4 v[120:123], v13, s[28:31], s83 offen offset:3072 sc1
    buffer_load_dwordx4 v[124:127], v13, s[28:31], s83 offen offset:3328 sc1
    s_waitcnt vmcnt(0)
    v_xor_b32 v14, s57, v127
    v_bitop3_b32 v14, v14, v123, s57 bitop3:0xf6
    v_bitop3_b32 v14, v14, v119, s57 bitop3:0xf6
    v_bitop3_b32 v14, v14, v115, s57 bitop3:0xf6
    v_bitop3_b32 v14, v14, v111, s57 bitop3:0xf6
    v_bitop3_b32 v14, v14, v107, s57 bitop3:0xf6
    v_and_b32 v14, v3, v14
    v_cmp_ne_u32 vcc, 0, v14
    s_add_u32 s50, s50, 1
    s_cmp_gt_u32 s50, 400000
    s_cbranch_scc1 C_G2_11
    s_cbranch_vccnz R_G2_11
    s_branch C_G2_11
R_G2_14:
    s_nop 3
    buffer_load_dwordx4 a[112:115], v13, s[28:31], s86 offen offset:3072 sc1
    buffer_load_dwordx4 a[116:119], v13, s[28:31], s86 offen offset:3328 sc1
    buffer_load_dwordx4 a[120:123], v13, s[28:31], s84 offen offset:0 sc1
    buffer_load_dwordx4 a[124:127], v13, s[28:31], s84 offen offset:256 sc1
    s_waitcnt vmcnt(0)
    v_accvgpr_read_b32 v15, a127
    v_xor_b32 v14, s57, v15
    v_accvgpr_read_b32 v15, a123
    v_bitop3_b32 v14, v14, v15, s57 bitop3:0xf6
    v_accvgpr_read_b32 v15, a119
    v_bitop3_b32 v14, v14, v15, s57 bitop3:0xf6
    v_accvgpr_read_b32 v15, a115
    v_bitop3_b32 v14, v14, v15, s57 bitop3:0xf6
    v_and_b32 v14, v3, v14
    v_cmp_ne_u32 vcc, 0, v14
    s_add_u32 s50, s50, 1
    s_cmp_gt_u32 s50, 400000
    s_cbranch_scc1 C_G2_14
    s_cbranch_vccnz R_G2_14
    s_branch C_G2_14
R_G2_16:
    s_nop 3
    buffer_load_dwordx4 v[4:7], v13, s[28:31], s85 offen offset:0 sc1
    buffer_load_dwordx4 v[8:11], v13, s[28:31], s85 offen offset:256 sc1
    buffer_load_dwordx4 v[88:91], v13, s[28:31], s84 offen offset:1024 sc1
    buffer_load_dwordx4 v[92:95], v13, s[28:31], s84 offen offset:1280 sc1
    s_waitcnt vmcnt(0)
    v_xor_b32 v14, s57, v95
    v_bitop3_b32 v14, v14, v91, s57 bitop3:0xf6
    v_bitop3_b32 v14, v14, v11, s57 bitop3:0xf6
    v_bitop3_b32 v14, v14, v7, s57 bitop3:0xf6
    v_and_b32 v14, v3, v14
    v_cmp_ne_u32 vcc, 0, v14
    s_add_u32 s50, s50, 1
    s_cmp_gt_u32 s50, 400000
    s_cbranch_scc1 C_G2_16
    s_cbranch_vccnz R_G2_16
    s_branch C_G2_16
R_G2_18:
    s_nop 3
    buffer_load_dwordx4 v[96:99], v13, s[28:31], s85 offen offset:1024 sc1
    buffer_load_dwordx4 v[100:103], v13, s[28:31], s85 offen offset:1280 sc1
    buffer_load_dwordx4 v[104:107], v13, s[28:31], s84 offen offset:2048 sc1
    buffer_load_dwordx4 v[108:111], v13, s[28:31], s84 offen offset:2304 sc1
    buffer_load_dwordx4 v[112:115], v13, s[28:31], s85 offen offset:2048 sc1
    buffer_load_dwordx4 v[116:119], v13, s[28:31], s85 offen offset:2304 sc1
    s_waitcnt vmcnt(0)
    v_xor_b32 v14, s57, v119
    v_bitop3_b32 v14, v14, v115, s57 bitop3:0xf6
    v_bitop3_b32 v14, v14, v111, s57 bitop3:0xf6
    v_bitop3_b32 v14, v14, v107, s57 bitop3:0xf6
    v_bitop3_b32 v14, v14, v103, s57 bitop3:0xf6
    v_bitop3_b32 v14, v14, v99, s57 bitop3:0xf6
    v_and_b32 v14, v3, v14
    v_cmp_ne_u32 vcc, 0, v14
    s_add_u32 s50, s50, 1
    s_cmp_gt_u32 s50, 400000
    s_cbranch_scc1 C_G2_18
    s_cbranch_vccnz R_G2_18
    s_branch C_G2_18
R_G2_21:
    s_nop 3
    buffer_load_dwordx4 v[120:123], v13, s[28:31], s89 offen offset:3072 sc1
    buffer_load_dwordx4 v[124:127], v13, s[28:31], s89 offen offset:3328 sc1
    buffer_load_dwordx4 a[112:115], v13, s[28:31], s87 offen offset:0 sc1
    buffer_load_dwordx4 a[116:119], v13, s[28:31], s87 offen offset:256 sc1
    s_waitcnt vmcnt(0)
    v_accvgpr_read_b32 v15, a119
    v_xor_b32 v14, s57, v15
    v_accvgpr_read_b32 v15, a115
    v_bitop3_b32 v14, v14, v15, s57 bitop3:0xf6
    v_bitop3_b32 v14, v14, v127, s57 bitop3:0xf6
    v_bitop3_b32 v14, v14, v123, s57 bitop3:0xf6
    v_and_b32 v14, v3, v14
    v_cmp_ne_u32 vcc, 0, v14
    s_add_u32 s50, s50, 1
    s_cmp_gt_u32 s50, 400000
    s_cbranch_scc1 C_G2_21
    s_cbranch_vccnz R_G2_21
    s_branch C_G2_21
R_G2_23:
    s_nop 3
    buffer_load_dwordx4 a[120:123], v13, s[28:31], s88 offen offset:0 sc1
    buffer_load_dwordx4 a[124:127], v13, s[28:31], s88 offen offset:256 sc1
    buffer_load_dwordx4 v[4:7], v13, s[28:31], s87 offen offset:1024 sc1
    buffer_load_dwordx4 v[8:11], v13, s[28:31], s87 offen offset:1280 sc1
    s_waitcnt vmcnt(0)
    v_xor_b32 v14, s57, v11
    v_bitop3_b32 v14, v14, v7, s57 bitop3:0xf6
    v_accvgpr_read_b32 v15, a127
    v_bitop3_b32 v14, v14, v15, s57 bitop3:0xf6
    v_accvgpr_read_b32 v15, a123
    v_bitop3_b32 v14, v14, v15, s57 bitop3:0xf6
    v_and_b32 v14, v3, v14
    v_cmp_ne_u32 vcc, 0, v14
    s_add_u32 s50, s50, 1
    s_cmp_gt_u32 s50, 400000
    s_cbranch_scc1 C_G2_23
    s_cbranch_vccnz R_G2_23
    s_branch C_G2_23
R_G2_25:
    s_nop 3
    buffer_load_dwordx4 v[88:91], v13, s[28:31], s88 offen offset:1024 sc1
    buffer_load_dwordx4 v[92:95], v13, s[28:31], s88 offen offset:1280 sc1
    buffer_load_dwordx4 v[96:99], v13, s[28:31], s87 offen offset:2048 sc1
    buffer_load_dwordx4 v[100:103], v13, s[28:31], s87 offen offset:2304 sc1
    buffer_load_dwordx4 v[104:107], v13, s[28:31], s88 offen offset:2048 sc1
    buffer_load_dwordx4 v[108:111], v13, s[28:31], s88 offen offset:2304 sc1
    s_waitcnt vmcnt(0)
    v_xor_b32 v14, s57, v111
    v_bitop3_b32 v14, v14, v107, s57 bitop3:0xf6
    v_bitop3_b32 v14, v14, v103, s57 bitop3:0xf6
    v_bitop3_b32 v14, v14, v99, s57 bitop3:0xf6
    v_bitop3_b32 v14, v14, v95, s57 bitop3:0xf6
    v_bitop3_b32 v14, v14, v91, s57 bitop3:0xf6
    v_and_b32 v14, v3, v14
    v_cmp_ne_u32 vcc, 0, v14
    s_add_u32 s50, s50, 1
    s_cmp_gt_u32 s50, 400000
    s_cbranch_scc1 C_G2_25
    s_cbranch_vccnz R_G2_25
    s_branch C_G2_25
CODE_END:
.section .rodata,"a"
.p2align 6
.amdhsa_kernel sequential_preLN__spectral_gfnet__glu_gated_geglu__prompt_kernel
  .amdhsa_next_free_vgpr 256
  .amdhsa_next_free_sgpr 102
  .amdhsa_accum_offset 128
  .amdhsa_group_segment_fixed_size 0
  .amdhsa_kernarg_size 80
  .amdhsa_user_sgpr_count 2
  .amdhsa_user_sgpr_kernarg_segment_ptr 1
  .amdhsa_system_sgpr_workgroup_id_x 1
.end_amdhsa_kernel
```
